```python
import torch

def _softmax(x, axis=-1):
    return torch.softmax(x, dim=axis)
def _gelu(x):
    return torch.nn.functional.gelu(x, approximate="tanh")
def _silu(x):
    return torch.nn.functional.silu(x)
def _sigmoid(x):
    return torch.sigmoid(x)
def _layernorm(x, axis=-1, eps=1e-5):
    m = x.mean(dim=axis, keepdim=True)
    v = x.var(dim=axis, keepdim=True, unbiased=False)
    return (x - m) / torch.sqrt(v + eps)
def _scatter_add(tgt, idx, src, axis=0):
    return tgt.clone().index_add_(axis, idx, src)
def _segment_sum(src, seg, n):
    out = torch.zeros((n,) + src.shape[1:], dtype=src.dtype)
    return out.index_add_(0, seg, src)
def _pad(x, pw):
    flat = tuple(v for pair in reversed(pw) for v in pair)
    return torch.nn.functional.pad(x, flat)

kernel_name = 'standalone__mha_block_cached__near_ridge'

def setup_inputs():

    _w = (lambda a: (lambda t: t.to(torch.bfloat16) if t.is_floating_point() else t)(torch.as_tensor(a)))
    B, Sq, D = 8, 128, 576
    H, Sk, Dh = 32, 1024, 128
    return {
        "x": _w((lambda *s: torch.randn(*s, dtype=torch.bfloat16) * 0.8)(B, Sq, D)),
        "k_cache": _w((lambda *s: torch.randn(*s, dtype=torch.bfloat16) * 0.8)(B, H, Sk, Dh)),
        "v_cache": _w((lambda *s: torch.randn(*s, dtype=torch.bfloat16) * 0.05)(B, H, Sk, Dh)),
        "wq": _w((lambda *s: torch.randn(*s, dtype=torch.bfloat16) * 0.8)(D, H * Dh) * (D ** -0.5)),
        "wo": _w((lambda *s: torch.randn(*s, dtype=torch.bfloat16) * 0.05)(H * Dh, D) * ((H * Dh) ** -0.5)),
    }

def reference(x, k_cache, v_cache, wq, wo):
    B, Sq, D = x.shape
    H, Dh = 32, 128
    q = (lambda x, *d: x.permute(*d))((x @ wq).reshape(B, Sq, H, Dh), 0, 2, 1, 3)
    scores = torch.einsum("bhqd,bhkd->bhqk", q, k_cache) * (Dh ** -0.5)
    p = _softmax(scores, axis=-1)
    o = torch.einsum("bhqk,bhkd->bhqd", p, v_cache)
    return (lambda x, *d: x.permute(*d))(o, 0, 2, 1, 3).reshape(B, Sq, H * Dh) @ wo
```

```asm
; @launch kernel=attn_kernel grid=(256,1,1) block=(512,1,1) lds=163840
; @launch kernel=oproj_kernel grid=(144,1,1) block=(256,1,1) lds=98304
.amdgcn_target "amdgcn-amd-amdhsa--gfx950"
.text
.globl attn_kernel
.p2align 8
.type attn_kernel,@function
attn_kernel:
    s_cmp_ge_u32 s2, 256
    s_cbranch_scc1 attn_kernel_done
    s_load_dwordx2 s[4:5], s[0:1], 8
    s_load_dwordx2 s[8:9], s[0:1], 16
    s_load_dwordx2 s[12:13], s[0:1], 0
    s_load_dwordx2 s[16:17], s[0:1], 24
    s_load_dwordx2 s[36:37], s[0:1], 56
    v_lshrrev_b32 v32, 6, v0
    v_and_b32 v1, 63, v0
    s_nop 0
    v_readfirstlane_b32 s21, v32
    s_waitcnt lgkmcnt(0)
    s_and_b32 s5, s5, 0xffff
    s_mov_b32 s6, 67108864
    s_mov_b32 s7, 0x00020000
    s_and_b32 s9, s9, 0xffff
    s_mov_b32 s10, 67108864
    s_mov_b32 s11, 0x00020000
    s_and_b32 s13, s13, 0xffff
    s_mov_b32 s14, 1179648
    s_mov_b32 s15, 0x00020000
    s_and_b32 s17, s17, 0xffff
    s_mov_b32 s18, 4718592
    s_mov_b32 s19, 0x00020000
    s_add_u32 s36, s36, 8388608
    s_addc_u32 s37, s37, 0
    s_and_b32 s37, s37, 0xffff
    s_mov_b32 s38, 8519680
    s_mov_b32 s39, 0x00020000
    s_and_b32 s22, s21, 3
    s_lshr_b32 s23, s21, 2
    s_mov_b32 s28, 0x3e0293ee
    s_mov_b32 s32, 0x41000000
    s_lshl_b32 s30, s21, 11
    s_lshl_b32 s24, s2, 18
    s_add_u32 s24, s24, s30
    s_lshr_b32 s25, s2, 5
    s_lshl_b32 s25, s25, 7
    s_lshl_b32 s26, s21, 4
    s_add_u32 s25, s25, s26
    s_mul_i32 s33, s25, 1152
    s_lshl_b32 s34, s21, 16
    s_and_b32 s26, s2, 31
    s_lshl_b32 s26, s26, 8
    s_add_u32 s34, s34, s26
    v_lshrrev_b32 v32, 4, v1
    v_and_b32 v33, 15, v1
    s_and_b32 s25, s21, 1
    s_lshl_b32 s25, s25, 3
    v_add_u32 v34, s25, v32
    v_xor_b32 v35, v33, v34
    v_lshlrev_b32 v35, 4, v35
    v_lshl_add_u32 v2, v32, 8, v35
    v_add_u32 v34, 4, v34
    v_xor_b32 v35, v33, v34
    v_lshlrev_b32 v35, 4, v35
    v_lshl_add_u32 v3, v32, 8, v35
    v_lshlrev_b32 v34, 2, v32
    v_xor_b32 v35, v33, v34
    v_lshlrev_b32 v35, 4, v35
    v_lshl_add_u32 v4, v32, 8, v35
    v_lshl_add_u32 v226, v32, 13, v35
    v_lshrrev_b32 v32, 3, v1
    v_mul_u32_u24 v32, 1152, v32
    v_and_b32 v33, 7, v1
    v_lshrrev_b32 v34, 4, v1
    v_xor_b32 v33, v33, v34
    v_lshl_add_u32 v224, v33, 4, v32
    v_xor_b32 v33, 4, v33
    v_lshl_add_u32 v225, v33, 4, v32
    s_add_u32 s25, s30, 0
    s_mov_b32 m0, s25
    s_add_u32 s26, s33, 0
    buffer_load_dwordx4 v224, s[12:15], s26 offen lds
    s_add_u32 s25, s30, 1024
    s_mov_b32 m0, s25
    s_add_u32 s26, s33, 9216
    buffer_load_dwordx4 v225, s[12:15], s26 offen lds
    s_add_u32 s25, s30, 16384
    s_mov_b32 m0, s25
    s_add_u32 s26, s34, 0
    buffer_load_dwordx4 v226, s[16:19], s26 offen lds
    s_add_u32 s25, s30, 17408
    s_mov_b32 m0, s25
    s_add_u32 s26, s34, 32768
    buffer_load_dwordx4 v226, s[16:19], s26 offen lds
    s_add_u32 s33, s33, 128
    s_add_u32 s34, s34, 524288
    s_add_u32 s25, s30, 32768
    s_mov_b32 m0, s25
    s_add_u32 s26, s33, 0
    buffer_load_dwordx4 v224, s[12:15], s26 offen lds
    s_add_u32 s25, s30, 33792
    s_mov_b32 m0, s25
    s_add_u32 s26, s33, 9216
    buffer_load_dwordx4 v225, s[12:15], s26 offen lds
    s_add_u32 s25, s30, 49152
    s_mov_b32 m0, s25
    s_add_u32 s26, s34, 0
    buffer_load_dwordx4 v226, s[16:19], s26 offen lds
    s_add_u32 s25, s30, 50176
    s_mov_b32 m0, s25
    s_add_u32 s26, s34, 32768
    buffer_load_dwordx4 v226, s[16:19], s26 offen lds
    s_add_u32 s33, s33, 128
    s_add_u32 s34, s34, 524288
    s_add_u32 s25, s30, 65536
    s_mov_b32 m0, s25
    s_add_u32 s26, s33, 0
    buffer_load_dwordx4 v224, s[12:15], s26 offen lds
    s_add_u32 s25, s30, 66560
    s_mov_b32 m0, s25
    s_add_u32 s26, s33, 9216
    buffer_load_dwordx4 v225, s[12:15], s26 offen lds
    s_add_u32 s25, s30, 81920
    s_mov_b32 m0, s25
    s_add_u32 s26, s34, 0
    buffer_load_dwordx4 v226, s[16:19], s26 offen lds
    s_add_u32 s25, s30, 82944
    s_mov_b32 m0, s25
    s_add_u32 s26, s34, 32768
    buffer_load_dwordx4 v226, s[16:19], s26 offen lds
    s_add_u32 s33, s33, 128
    s_add_u32 s34, s34, 524288
    s_lshl_b32 s25, s23, 5
    v_and_b32 v32, 31, v1
    v_add_u32 v32, s25, v32
    v_lshlrev_b32 v32, 8, v32
    v_lshrrev_b32 v33, 5, v1
    v_and_b32 v34, 15, v1
    v_xor_b32 v33, v33, v34
    v_xor_b32 v34, 0, v33
    v_lshl_add_u32 v5, v34, 4, v32
    v_xor_b32 v34, 2, v33
    v_lshl_add_u32 v6, v34, 4, v32
    v_xor_b32 v34, 4, v33
    v_lshl_add_u32 v7, v34, 4, v32
    v_xor_b32 v34, 6, v33
    v_lshl_add_u32 v8, v34, 4, v32
    v_xor_b32 v34, 8, v33
    v_lshl_add_u32 v9, v34, 4, v32
    v_xor_b32 v34, 10, v33
    v_lshl_add_u32 v10, v34, 4, v32
    v_xor_b32 v34, 12, v33
    v_lshl_add_u32 v11, v34, 4, v32
    v_xor_b32 v34, 14, v33
    v_lshl_add_u32 v12, v34, 4, v32
    v_lshrrev_b32 v36, 5, v1
    v_lshrrev_b32 v33, 2, v1
    v_and_b32 v33, 3, v33
    v_lshlrev_b32 v32, 2, v36
    v_add_u32 v32, v32, v33
    v_add_u32 v32, s25, v32
    v_lshlrev_b32 v32, 8, v32
    v_add_u32 v32, 16384, v32
    v_and_b32 v34, 1, v1
    v_lshl_add_u32 v32, v34, 3, v32
    v_lshlrev_b32 v37, 3, v36
    v_add_u32 v37, v37, v33
    v_lshlrev_b32 v37, 8, v37
    v_add_u32 v37, 16384, v37
    v_lshl_add_u32 v37, v34, 3, v37
    v_lshlrev_b32 v33, 2, v33
    v_lshrrev_b32 v34, 4, v1
    v_and_b32 v34, 1, v34
    v_lshlrev_b32 v34, 1, v34
    v_lshrrev_b32 v35, 1, v1
    v_and_b32 v35, 1, v35
    v_add_u32 v34, v34, v35
    v_add_u32 v35, 0, v34
    v_xor_b32 v35, v35, v33
    v_lshl_add_u32 v13, v35, 4, v32
    v_add_u32 v35, 4, v34
    v_xor_b32 v35, v35, v33
    v_lshl_add_u32 v14, v35, 4, v32
    v_add_u32 v35, 8, v34
    v_xor_b32 v35, v35, v33
    v_lshl_add_u32 v15, v35, 4, v32
    v_add_u32 v35, 12, v34
    v_xor_b32 v35, v35, v33
    v_lshl_add_u32 v16, v35, 4, v32
    s_lshl_b32 s26, s23, 3
    v_add_u32 v35, s26, v34
    v_xor_b32 v35, v35, v33
    v_lshl_add_u32 v40, v35, 4, v37
    v_add_u32 v42, 65536, v40
    v_add_u32 v35, s26, v34
    v_add_u32 v35, 4, v35
    v_xor_b32 v35, v35, v33
    v_lshl_add_u32 v41, v35, 4, v37
    v_add_u32 v43, 65536, v41
    s_lshl_b32 s26, s22, 5
    v_and_b32 v32, 31, v1
    v_add_u32 v32, s26, v32
    v_lshlrev_b32 v32, 7, v32
    v_lshrrev_b32 v33, 1, v1
    v_and_b32 v33, 7, v33
    v_xor_b32 v33, v33, v36
    v_xor_b32 v34, 0, v33
    v_lshl_add_u32 v227, v34, 4, v32
    v_add_u32 v44, 65536, v227
    v_xor_b32 v34, 2, v33
    v_lshl_add_u32 v228, v34, 4, v32
    v_add_u32 v45, 65536, v228
    v_xor_b32 v34, 4, v33
    v_lshl_add_u32 v229, v34, 4, v32
    v_add_u32 v46, 65536, v229
    v_xor_b32 v34, 6, v33
    v_lshl_add_u32 v230, v34, 4, v32
    v_add_u32 v47, 65536, v230
    v_add_u32 v17, 65536, v5
    v_add_u32 v18, 65536, v6
    v_add_u32 v19, 65536, v7
    v_add_u32 v20, 65536, v8
    v_add_u32 v21, 65536, v9
    v_add_u32 v22, 65536, v10
    v_add_u32 v23, 65536, v11
    v_add_u32 v24, 65536, v12
    v_add_u32 v25, 65536, v13
    v_add_u32 v26, 65536, v14
    v_add_u32 v27, 65536, v15
    v_add_u32 v28, 65536, v16
    v_mov_b32 v29, 0xff800000
    v_mov_b32 v30, 0
    v_mov_b32 v160, 0
    v_mov_b32 v161, 0
    v_mov_b32 v162, 0
    v_mov_b32 v163, 0
    v_mov_b32 v164, 0
    v_mov_b32 v165, 0
    v_mov_b32 v166, 0
    v_mov_b32 v167, 0
    v_mov_b32 v168, 0
    v_mov_b32 v169, 0
    v_mov_b32 v170, 0
    v_mov_b32 v171, 0
    v_mov_b32 v172, 0
    v_mov_b32 v173, 0
    v_mov_b32 v174, 0
    v_mov_b32 v175, 0
    v_mov_b32 v176, 0
    v_mov_b32 v177, 0
    v_mov_b32 v178, 0
    v_mov_b32 v179, 0
    v_mov_b32 v180, 0
    v_mov_b32 v181, 0
    v_mov_b32 v182, 0
    v_mov_b32 v183, 0
    v_mov_b32 v184, 0
    v_mov_b32 v185, 0
    v_mov_b32 v186, 0
    v_mov_b32 v187, 0
    v_mov_b32 v188, 0
    v_mov_b32 v189, 0
    v_mov_b32 v190, 0
    v_mov_b32 v191, 0
    s_waitcnt vmcnt(8)
    s_barrier
    s_add_u32 s25, s30, 98304
    s_mov_b32 m0, s25
    s_add_u32 s26, s33, 0
    buffer_load_dwordx4 v224, s[12:15], s26 offen lds
    s_add_u32 s25, s30, 99328
    s_mov_b32 m0, s25
    s_add_u32 s26, s33, 9216
    buffer_load_dwordx4 v225, s[12:15], s26 offen lds
    s_add_u32 s25, s30, 114688
    s_mov_b32 m0, s25
    s_add_u32 s26, s34, 0
    buffer_load_dwordx4 v226, s[16:19], s26 offen lds
    s_add_u32 s25, s30, 115712
    s_mov_b32 m0, s25
    s_add_u32 s26, s34, 32768
    buffer_load_dwordx4 v226, s[16:19], s26 offen lds
    s_add_u32 s33, s33, 128
    s_add_u32 s34, s34, 524288
    ds_read_b128 v[96:99], v227 offset:0
    ds_read_b64_tr_b16 v[128:129], v40 offset:0
    ds_read_b64_tr_b16 v[130:131], v40 offset:1024
    ds_read_b64_tr_b16 v[132:133], v41 offset:0
    ds_read_b64_tr_b16 v[134:135], v41 offset:1024
    ds_read_b128 v[100:103], v228 offset:0
    ds_read_b64_tr_b16 v[136:137], v40 offset:4096
    ds_read_b64_tr_b16 v[138:139], v40 offset:5120
    ds_read_b64_tr_b16 v[140:141], v41 offset:4096
    ds_read_b64_tr_b16 v[142:143], v41 offset:5120
    ds_read_b128 v[104:107], v229 offset:0
    ds_read_b64_tr_b16 v[144:145], v40 offset:8192
    ds_read_b64_tr_b16 v[146:147], v40 offset:9216
    ds_read_b64_tr_b16 v[148:149], v41 offset:8192
    ds_read_b64_tr_b16 v[150:151], v41 offset:9216
    s_waitcnt lgkmcnt(10)
    v_mfma_f32_32x32x16_bf16 v[160:175], v[128:131], v[96:99], v[160:175]
    v_mfma_f32_32x32x16_bf16 v[176:191], v[132:135], v[96:99], v[176:191]
    ds_read_b128 v[108:111], v230 offset:0
    ds_read_b64_tr_b16 v[152:153], v40 offset:12288
    ds_read_b64_tr_b16 v[154:155], v40 offset:13312
    ds_read_b64_tr_b16 v[156:157], v41 offset:12288
    ds_read_b64_tr_b16 v[158:159], v41 offset:13312
    s_waitcnt lgkmcnt(10)
    v_mfma_f32_32x32x16_bf16 v[160:175], v[136:139], v[100:103], v[160:175]
    v_mfma_f32_32x32x16_bf16 v[176:191], v[140:143], v[100:103], v[176:191]
    s_waitcnt lgkmcnt(5)
    v_mfma_f32_32x32x16_bf16 v[160:175], v[144:147], v[104:107], v[160:175]
    v_mfma_f32_32x32x16_bf16 v[176:191], v[148:151], v[104:107], v[176:191]
    s_waitcnt lgkmcnt(0)
    v_mfma_f32_32x32x16_bf16 v[160:175], v[152:155], v[108:111], v[160:175]
    v_mfma_f32_32x32x16_bf16 v[176:191], v[156:159], v[108:111], v[176:191]
    s_waitcnt vmcnt(8)
    s_barrier
    s_add_u32 s25, s30, 0
    s_mov_b32 m0, s25
    s_add_u32 s26, s33, 0
    buffer_load_dwordx4 v224, s[12:15], s26 offen lds
    s_add_u32 s25, s30, 1024
    s_mov_b32 m0, s25
    s_add_u32 s26, s33, 9216
    buffer_load_dwordx4 v225, s[12:15], s26 offen lds
    s_add_u32 s25, s30, 16384
    s_mov_b32 m0, s25
    s_add_u32 s26, s34, 0
    buffer_load_dwordx4 v226, s[16:19], s26 offen lds
    s_add_u32 s25, s30, 17408
    s_mov_b32 m0, s25
    s_add_u32 s26, s34, 32768
    buffer_load_dwordx4 v226, s[16:19], s26 offen lds
    s_add_u32 s33, s33, 128
    s_add_u32 s34, s34, 524288
    ds_read_b128 v[96:99], v227 offset:32768
    ds_read_b64_tr_b16 v[128:129], v40 offset:32768
    ds_read_b64_tr_b16 v[130:131], v40 offset:33792
    ds_read_b64_tr_b16 v[132:133], v41 offset:32768
    ds_read_b64_tr_b16 v[134:135], v41 offset:33792
    ds_read_b128 v[100:103], v228 offset:32768
    ds_read_b64_tr_b16 v[136:137], v40 offset:36864
    ds_read_b64_tr_b16 v[138:139], v40 offset:37888
    ds_read_b64_tr_b16 v[140:141], v41 offset:36864
    ds_read_b64_tr_b16 v[142:143], v41 offset:37888
    ds_read_b128 v[104:107], v229 offset:32768
    ds_read_b64_tr_b16 v[144:145], v40 offset:40960
    ds_read_b64_tr_b16 v[146:147], v40 offset:41984
    ds_read_b64_tr_b16 v[148:149], v41 offset:40960
    ds_read_b64_tr_b16 v[150:151], v41 offset:41984
    s_waitcnt lgkmcnt(10)
    v_mfma_f32_32x32x16_bf16 v[160:175], v[128:131], v[96:99], v[160:175]
    v_mfma_f32_32x32x16_bf16 v[176:191], v[132:135], v[96:99], v[176:191]
    ds_read_b128 v[108:111], v230 offset:32768
    ds_read_b64_tr_b16 v[152:153], v40 offset:45056
    ds_read_b64_tr_b16 v[154:155], v40 offset:46080
    ds_read_b64_tr_b16 v[156:157], v41 offset:45056
    ds_read_b64_tr_b16 v[158:159], v41 offset:46080
    s_waitcnt lgkmcnt(10)
    v_mfma_f32_32x32x16_bf16 v[160:175], v[136:139], v[100:103], v[160:175]
    v_mfma_f32_32x32x16_bf16 v[176:191], v[140:143], v[100:103], v[176:191]
    s_waitcnt lgkmcnt(5)
    v_mfma_f32_32x32x16_bf16 v[160:175], v[144:147], v[104:107], v[160:175]
    v_mfma_f32_32x32x16_bf16 v[176:191], v[148:151], v[104:107], v[176:191]
    s_waitcnt lgkmcnt(0)
    v_mfma_f32_32x32x16_bf16 v[160:175], v[152:155], v[108:111], v[160:175]
    v_mfma_f32_32x32x16_bf16 v[176:191], v[156:159], v[108:111], v[176:191]
    s_waitcnt vmcnt(8)
    s_barrier
    s_add_u32 s25, s30, 32768
    s_mov_b32 m0, s25
    s_add_u32 s26, s33, 0
    buffer_load_dwordx4 v224, s[12:15], s26 offen lds
    s_add_u32 s25, s30, 33792
    s_mov_b32 m0, s25
    s_add_u32 s26, s33, 9216
    buffer_load_dwordx4 v225, s[12:15], s26 offen lds
    s_add_u32 s25, s30, 49152
    s_mov_b32 m0, s25
    s_add_u32 s26, s34, 0
    buffer_load_dwordx4 v226, s[16:19], s26 offen lds
    s_add_u32 s25, s30, 50176
    s_mov_b32 m0, s25
    s_add_u32 s26, s34, 32768
    buffer_load_dwordx4 v226, s[16:19], s26 offen lds
    s_add_u32 s33, s33, 128
    s_add_u32 s34, s34, 524288
    ds_read_b128 v[96:99], v44 offset:0
    ds_read_b64_tr_b16 v[128:129], v42 offset:0
    ds_read_b64_tr_b16 v[130:131], v42 offset:1024
    ds_read_b64_tr_b16 v[132:133], v43 offset:0
    ds_read_b64_tr_b16 v[134:135], v43 offset:1024
    ds_read_b128 v[100:103], v45 offset:0
    ds_read_b64_tr_b16 v[136:137], v42 offset:4096
    ds_read_b64_tr_b16 v[138:139], v42 offset:5120
    ds_read_b64_tr_b16 v[140:141], v43 offset:4096
    ds_read_b64_tr_b16 v[142:143], v43 offset:5120
    ds_read_b128 v[104:107], v46 offset:0
    ds_read_b64_tr_b16 v[144:145], v42 offset:8192
    ds_read_b64_tr_b16 v[146:147], v42 offset:9216
    ds_read_b64_tr_b16 v[148:149], v43 offset:8192
    ds_read_b64_tr_b16 v[150:151], v43 offset:9216
    s_waitcnt lgkmcnt(10)
    v_mfma_f32_32x32x16_bf16 v[160:175], v[128:131], v[96:99], v[160:175]
    v_mfma_f32_32x32x16_bf16 v[176:191], v[132:135], v[96:99], v[176:191]
    ds_read_b128 v[108:111], v47 offset:0
    ds_read_b64_tr_b16 v[152:153], v42 offset:12288
    ds_read_b64_tr_b16 v[154:155], v42 offset:13312
    ds_read_b64_tr_b16 v[156:157], v43 offset:12288
    ds_read_b64_tr_b16 v[158:159], v43 offset:13312
    s_waitcnt lgkmcnt(10)
    v_mfma_f32_32x32x16_bf16 v[160:175], v[136:139], v[100:103], v[160:175]
    v_mfma_f32_32x32x16_bf16 v[176:191], v[140:143], v[100:103], v[176:191]
    s_waitcnt lgkmcnt(5)
    v_mfma_f32_32x32x16_bf16 v[160:175], v[144:147], v[104:107], v[160:175]
    v_mfma_f32_32x32x16_bf16 v[176:191], v[148:151], v[104:107], v[176:191]
    s_waitcnt lgkmcnt(0)
    v_mfma_f32_32x32x16_bf16 v[160:175], v[152:155], v[108:111], v[160:175]
    v_mfma_f32_32x32x16_bf16 v[176:191], v[156:159], v[108:111], v[176:191]
    s_waitcnt vmcnt(8)
    s_barrier
    s_add_u32 s25, s30, 65536
    s_mov_b32 m0, s25
    s_add_u32 s26, s33, 0
    buffer_load_dwordx4 v224, s[12:15], s26 offen lds
    s_add_u32 s25, s30, 66560
    s_mov_b32 m0, s25
    s_add_u32 s26, s33, 9216
    buffer_load_dwordx4 v225, s[12:15], s26 offen lds
    s_add_u32 s25, s30, 81920
    s_mov_b32 m0, s25
    s_add_u32 s26, s34, 0
    buffer_load_dwordx4 v226, s[16:19], s26 offen lds
    s_add_u32 s25, s30, 82944
    s_mov_b32 m0, s25
    s_add_u32 s26, s34, 32768
    buffer_load_dwordx4 v226, s[16:19], s26 offen lds
    s_add_u32 s33, s33, 128
    s_add_u32 s34, s34, 524288
    ds_read_b128 v[96:99], v44 offset:32768
    ds_read_b64_tr_b16 v[128:129], v42 offset:32768
    ds_read_b64_tr_b16 v[130:131], v42 offset:33792
    ds_read_b64_tr_b16 v[132:133], v43 offset:32768
    ds_read_b64_tr_b16 v[134:135], v43 offset:33792
    ds_read_b128 v[100:103], v45 offset:32768
    ds_read_b64_tr_b16 v[136:137], v42 offset:36864
    ds_read_b64_tr_b16 v[138:139], v42 offset:37888
    ds_read_b64_tr_b16 v[140:141], v43 offset:36864
    ds_read_b64_tr_b16 v[142:143], v43 offset:37888
    ds_read_b128 v[104:107], v46 offset:32768
    ds_read_b64_tr_b16 v[144:145], v42 offset:40960
    ds_read_b64_tr_b16 v[146:147], v42 offset:41984
    ds_read_b64_tr_b16 v[148:149], v43 offset:40960
    ds_read_b64_tr_b16 v[150:151], v43 offset:41984
    s_waitcnt lgkmcnt(10)
    v_mfma_f32_32x32x16_bf16 v[160:175], v[128:131], v[96:99], v[160:175]
    v_mfma_f32_32x32x16_bf16 v[176:191], v[132:135], v[96:99], v[176:191]
    ds_read_b128 v[108:111], v47 offset:32768
    ds_read_b64_tr_b16 v[152:153], v42 offset:45056
    ds_read_b64_tr_b16 v[154:155], v42 offset:46080
    ds_read_b64_tr_b16 v[156:157], v43 offset:45056
    ds_read_b64_tr_b16 v[158:159], v43 offset:46080
    s_waitcnt lgkmcnt(10)
    v_mfma_f32_32x32x16_bf16 v[160:175], v[136:139], v[100:103], v[160:175]
    v_mfma_f32_32x32x16_bf16 v[176:191], v[140:143], v[100:103], v[176:191]
    s_waitcnt lgkmcnt(5)
    v_mfma_f32_32x32x16_bf16 v[160:175], v[144:147], v[104:107], v[160:175]
    v_mfma_f32_32x32x16_bf16 v[176:191], v[148:151], v[104:107], v[176:191]
    s_waitcnt lgkmcnt(0)
    v_mfma_f32_32x32x16_bf16 v[160:175], v[152:155], v[108:111], v[160:175]
    v_mfma_f32_32x32x16_bf16 v[176:191], v[156:159], v[108:111], v[176:191]
    s_waitcnt vmcnt(8)
    s_barrier
    s_add_u32 s25, s30, 98304
    s_mov_b32 m0, s25
    s_add_u32 s26, s33, 0
    buffer_load_dwordx4 v224, s[12:15], s26 offen lds
    s_add_u32 s25, s30, 99328
    s_mov_b32 m0, s25
    s_add_u32 s26, s33, 9216
    buffer_load_dwordx4 v225, s[12:15], s26 offen lds
    s_add_u32 s25, s30, 114688
    s_mov_b32 m0, s25
    s_add_u32 s26, s34, 0
    buffer_load_dwordx4 v226, s[16:19], s26 offen lds
    s_add_u32 s25, s30, 115712
    s_mov_b32 m0, s25
    s_add_u32 s26, s34, 32768
    buffer_load_dwordx4 v226, s[16:19], s26 offen lds
    s_add_u32 s33, s33, 128
    s_add_u32 s34, s34, 524288
    ds_read_b128 v[96:99], v227 offset:0
    ds_read_b64_tr_b16 v[128:129], v40 offset:0
    ds_read_b64_tr_b16 v[130:131], v40 offset:1024
    ds_read_b64_tr_b16 v[132:133], v41 offset:0
    ds_read_b64_tr_b16 v[134:135], v41 offset:1024
    ds_read_b128 v[100:103], v228 offset:0
    ds_read_b64_tr_b16 v[136:137], v40 offset:4096
    ds_read_b64_tr_b16 v[138:139], v40 offset:5120
    ds_read_b64_tr_b16 v[140:141], v41 offset:4096
    ds_read_b64_tr_b16 v[142:143], v41 offset:5120
    ds_read_b128 v[104:107], v229 offset:0
    ds_read_b64_tr_b16 v[144:145], v40 offset:8192
    ds_read_b64_tr_b16 v[146:147], v40 offset:9216
    ds_read_b64_tr_b16 v[148:149], v41 offset:8192
    ds_read_b64_tr_b16 v[150:151], v41 offset:9216
    s_waitcnt lgkmcnt(10)
    v_mfma_f32_32x32x16_bf16 v[160:175], v[128:131], v[96:99], v[160:175]
    v_mfma_f32_32x32x16_bf16 v[176:191], v[132:135], v[96:99], v[176:191]
    ds_read_b128 v[108:111], v230 offset:0
    ds_read_b64_tr_b16 v[152:153], v40 offset:12288
    ds_read_b64_tr_b16 v[154:155], v40 offset:13312
    ds_read_b64_tr_b16 v[156:157], v41 offset:12288
    ds_read_b64_tr_b16 v[158:159], v41 offset:13312
    s_waitcnt lgkmcnt(10)
    v_mfma_f32_32x32x16_bf16 v[160:175], v[136:139], v[100:103], v[160:175]
    v_mfma_f32_32x32x16_bf16 v[176:191], v[140:143], v[100:103], v[176:191]
    s_waitcnt lgkmcnt(5)
    v_mfma_f32_32x32x16_bf16 v[160:175], v[144:147], v[104:107], v[160:175]
    v_mfma_f32_32x32x16_bf16 v[176:191], v[148:151], v[104:107], v[176:191]
    s_waitcnt lgkmcnt(0)
    v_mfma_f32_32x32x16_bf16 v[160:175], v[152:155], v[108:111], v[160:175]
    v_mfma_f32_32x32x16_bf16 v[176:191], v[156:159], v[108:111], v[176:191]
    s_waitcnt vmcnt(8)
    s_barrier
    s_add_u32 s25, s30, 0
    s_mov_b32 m0, s25
    s_add_u32 s26, s33, 0
    buffer_load_dwordx4 v224, s[12:15], s26 offen lds
    s_add_u32 s25, s30, 1024
    s_mov_b32 m0, s25
    s_add_u32 s26, s33, 9216
    buffer_load_dwordx4 v225, s[12:15], s26 offen lds
    s_add_u32 s25, s30, 16384
    s_mov_b32 m0, s25
    s_add_u32 s26, s34, 0
    buffer_load_dwordx4 v226, s[16:19], s26 offen lds
    s_add_u32 s25, s30, 17408
    s_mov_b32 m0, s25
    s_add_u32 s26, s34, 32768
    buffer_load_dwordx4 v226, s[16:19], s26 offen lds
    s_add_u32 s33, s33, 128
    s_add_u32 s34, s34, 524288
    ds_read_b128 v[96:99], v227 offset:32768
    ds_read_b64_tr_b16 v[128:129], v40 offset:32768
    ds_read_b64_tr_b16 v[130:131], v40 offset:33792
    ds_read_b64_tr_b16 v[132:133], v41 offset:32768
    ds_read_b64_tr_b16 v[134:135], v41 offset:33792
    ds_read_b128 v[100:103], v228 offset:32768
    ds_read_b64_tr_b16 v[136:137], v40 offset:36864
    ds_read_b64_tr_b16 v[138:139], v40 offset:37888
    ds_read_b64_tr_b16 v[140:141], v41 offset:36864
    ds_read_b64_tr_b16 v[142:143], v41 offset:37888
    ds_read_b128 v[104:107], v229 offset:32768
    ds_read_b64_tr_b16 v[144:145], v40 offset:40960
    ds_read_b64_tr_b16 v[146:147], v40 offset:41984
    ds_read_b64_tr_b16 v[148:149], v41 offset:40960
    ds_read_b64_tr_b16 v[150:151], v41 offset:41984
    s_waitcnt lgkmcnt(10)
    v_mfma_f32_32x32x16_bf16 v[160:175], v[128:131], v[96:99], v[160:175]
    v_mfma_f32_32x32x16_bf16 v[176:191], v[132:135], v[96:99], v[176:191]
    ds_read_b128 v[108:111], v230 offset:32768
    ds_read_b64_tr_b16 v[152:153], v40 offset:45056
    ds_read_b64_tr_b16 v[154:155], v40 offset:46080
    ds_read_b64_tr_b16 v[156:157], v41 offset:45056
    ds_read_b64_tr_b16 v[158:159], v41 offset:46080
    s_waitcnt lgkmcnt(10)
    v_mfma_f32_32x32x16_bf16 v[160:175], v[136:139], v[100:103], v[160:175]
    v_mfma_f32_32x32x16_bf16 v[176:191], v[140:143], v[100:103], v[176:191]
    s_waitcnt lgkmcnt(5)
    v_mfma_f32_32x32x16_bf16 v[160:175], v[144:147], v[104:107], v[160:175]
    v_mfma_f32_32x32x16_bf16 v[176:191], v[148:151], v[104:107], v[176:191]
    s_waitcnt lgkmcnt(0)
    v_mfma_f32_32x32x16_bf16 v[160:175], v[152:155], v[108:111], v[160:175]
    v_mfma_f32_32x32x16_bf16 v[176:191], v[156:159], v[108:111], v[176:191]
    s_waitcnt vmcnt(8)
    s_barrier
    s_add_u32 s25, s30, 32768
    s_mov_b32 m0, s25
    s_add_u32 s26, s24, 0
    buffer_load_dwordx4 v2, s[4:7], s26 offen nt lds
    s_add_u32 s25, s30, 33792
    s_mov_b32 m0, s25
    s_add_u32 s26, s24, 1024
    buffer_load_dwordx4 v3, s[4:7], s26 offen nt lds
    s_add_u32 s25, s30, 49152
    s_mov_b32 m0, s25
    s_add_u32 s26, s24, 0
    buffer_load_dwordx4 v4, s[8:11], s26 offen nt lds
    s_add_u32 s25, s30, 50176
    s_mov_b32 m0, s25
    s_add_u32 s26, s24, 1024
    buffer_load_dwordx4 v4, s[8:11], s26 offen nt lds
    s_add_u32 s24, s24, 16384
    ds_read_b128 v[96:99], v44 offset:0
    ds_read_b64_tr_b16 v[128:129], v42 offset:0
    ds_read_b64_tr_b16 v[130:131], v42 offset:1024
    ds_read_b64_tr_b16 v[132:133], v43 offset:0
    ds_read_b64_tr_b16 v[134:135], v43 offset:1024
    ds_read_b128 v[100:103], v45 offset:0
    ds_read_b64_tr_b16 v[136:137], v42 offset:4096
    ds_read_b64_tr_b16 v[138:139], v42 offset:5120
    ds_read_b64_tr_b16 v[140:141], v43 offset:4096
    ds_read_b64_tr_b16 v[142:143], v43 offset:5120
    ds_read_b128 v[104:107], v46 offset:0
    ds_read_b64_tr_b16 v[144:145], v42 offset:8192
    ds_read_b64_tr_b16 v[146:147], v42 offset:9216
    ds_read_b64_tr_b16 v[148:149], v43 offset:8192
    ds_read_b64_tr_b16 v[150:151], v43 offset:9216
    s_waitcnt lgkmcnt(10)
    v_mfma_f32_32x32x16_bf16 v[160:175], v[128:131], v[96:99], v[160:175]
    v_mfma_f32_32x32x16_bf16 v[176:191], v[132:135], v[96:99], v[176:191]
    ds_read_b128 v[108:111], v47 offset:0
    ds_read_b64_tr_b16 v[152:153], v42 offset:12288
    ds_read_b64_tr_b16 v[154:155], v42 offset:13312
    ds_read_b64_tr_b16 v[156:157], v43 offset:12288
    ds_read_b64_tr_b16 v[158:159], v43 offset:13312
    s_waitcnt lgkmcnt(10)
    v_mfma_f32_32x32x16_bf16 v[160:175], v[136:139], v[100:103], v[160:175]
    v_mfma_f32_32x32x16_bf16 v[176:191], v[140:143], v[100:103], v[176:191]
    s_waitcnt lgkmcnt(5)
    v_mfma_f32_32x32x16_bf16 v[160:175], v[144:147], v[104:107], v[160:175]
    v_mfma_f32_32x32x16_bf16 v[176:191], v[148:151], v[104:107], v[176:191]
    s_waitcnt lgkmcnt(0)
    v_mfma_f32_32x32x16_bf16 v[160:175], v[152:155], v[108:111], v[160:175]
    v_mfma_f32_32x32x16_bf16 v[176:191], v[156:159], v[108:111], v[176:191]
    s_waitcnt vmcnt(8)
    s_barrier
    s_add_u32 s25, s30, 65536
    s_mov_b32 m0, s25
    s_add_u32 s26, s24, 0
    buffer_load_dwordx4 v2, s[4:7], s26 offen nt lds
    s_add_u32 s25, s30, 66560
    s_mov_b32 m0, s25
    s_add_u32 s26, s24, 1024
    buffer_load_dwordx4 v3, s[4:7], s26 offen nt lds
    s_add_u32 s25, s30, 81920
    s_mov_b32 m0, s25
    s_add_u32 s26, s24, 0
    buffer_load_dwordx4 v4, s[8:11], s26 offen nt lds
    s_add_u32 s25, s30, 82944
    s_mov_b32 m0, s25
    s_add_u32 s26, s24, 1024
    buffer_load_dwordx4 v4, s[8:11], s26 offen nt lds
    s_add_u32 s24, s24, 16384
    ds_read_b128 v[96:99], v44 offset:32768
    ds_read_b64_tr_b16 v[128:129], v42 offset:32768
    ds_read_b64_tr_b16 v[130:131], v42 offset:33792
    ds_read_b64_tr_b16 v[132:133], v43 offset:32768
    ds_read_b64_tr_b16 v[134:135], v43 offset:33792
    ds_read_b128 v[100:103], v45 offset:32768
    ds_read_b64_tr_b16 v[136:137], v42 offset:36864
    ds_read_b64_tr_b16 v[138:139], v42 offset:37888
    ds_read_b64_tr_b16 v[140:141], v43 offset:36864
    ds_read_b64_tr_b16 v[142:143], v43 offset:37888
    ds_read_b128 v[104:107], v46 offset:32768
    ds_read_b64_tr_b16 v[144:145], v42 offset:40960
    ds_read_b64_tr_b16 v[146:147], v42 offset:41984
    ds_read_b64_tr_b16 v[148:149], v43 offset:40960
    ds_read_b64_tr_b16 v[150:151], v43 offset:41984
    s_waitcnt lgkmcnt(10)
    v_mfma_f32_32x32x16_bf16 v[160:175], v[128:131], v[96:99], v[160:175]
    v_mfma_f32_32x32x16_bf16 v[176:191], v[132:135], v[96:99], v[176:191]
    ds_read_b128 v[108:111], v47 offset:32768
    ds_read_b64_tr_b16 v[152:153], v42 offset:45056
    ds_read_b64_tr_b16 v[154:155], v42 offset:46080
    ds_read_b64_tr_b16 v[156:157], v43 offset:45056
    ds_read_b64_tr_b16 v[158:159], v43 offset:46080
    s_waitcnt lgkmcnt(10)
    v_mfma_f32_32x32x16_bf16 v[160:175], v[136:139], v[100:103], v[160:175]
    v_mfma_f32_32x32x16_bf16 v[176:191], v[140:143], v[100:103], v[176:191]
    s_waitcnt lgkmcnt(5)
    v_mfma_f32_32x32x16_bf16 v[160:175], v[144:147], v[104:107], v[160:175]
    v_mfma_f32_32x32x16_bf16 v[176:191], v[148:151], v[104:107], v[176:191]
    s_waitcnt lgkmcnt(0)
    v_mfma_f32_32x32x16_bf16 v[160:175], v[152:155], v[108:111], v[160:175]
    v_mfma_f32_32x32x16_bf16 v[176:191], v[156:159], v[108:111], v[176:191]
    s_waitcnt vmcnt(8)
    s_barrier
    s_add_u32 s25, s30, 98304
    s_mov_b32 m0, s25
    s_add_u32 s26, s24, 0
    buffer_load_dwordx4 v2, s[4:7], s26 offen nt lds
    s_add_u32 s25, s30, 99328
    s_mov_b32 m0, s25
    s_add_u32 s26, s24, 1024
    buffer_load_dwordx4 v3, s[4:7], s26 offen nt lds
    s_add_u32 s25, s30, 114688
    s_mov_b32 m0, s25
    s_add_u32 s26, s24, 0
    buffer_load_dwordx4 v4, s[8:11], s26 offen nt lds
    s_add_u32 s25, s30, 115712
    s_mov_b32 m0, s25
    s_add_u32 s26, s24, 1024
    buffer_load_dwordx4 v4, s[8:11], s26 offen nt lds
    s_add_u32 s24, s24, 16384
    ds_read_b128 v[96:99], v227 offset:0
    ds_read_b64_tr_b16 v[128:129], v40 offset:0
    ds_read_b64_tr_b16 v[130:131], v40 offset:1024
    ds_read_b64_tr_b16 v[132:133], v41 offset:0
    ds_read_b64_tr_b16 v[134:135], v41 offset:1024
    ds_read_b128 v[100:103], v228 offset:0
    ds_read_b64_tr_b16 v[136:137], v40 offset:4096
    ds_read_b64_tr_b16 v[138:139], v40 offset:5120
    ds_read_b64_tr_b16 v[140:141], v41 offset:4096
    ds_read_b64_tr_b16 v[142:143], v41 offset:5120
    ds_read_b128 v[104:107], v229 offset:0
    ds_read_b64_tr_b16 v[144:145], v40 offset:8192
    ds_read_b64_tr_b16 v[146:147], v40 offset:9216
    ds_read_b64_tr_b16 v[148:149], v41 offset:8192
    ds_read_b64_tr_b16 v[150:151], v41 offset:9216
    s_waitcnt lgkmcnt(10)
    v_mfma_f32_32x32x16_bf16 v[160:175], v[128:131], v[96:99], v[160:175]
    v_mfma_f32_32x32x16_bf16 v[176:191], v[132:135], v[96:99], v[176:191]
    ds_read_b128 v[108:111], v230 offset:0
    ds_read_b64_tr_b16 v[152:153], v40 offset:12288
    ds_read_b64_tr_b16 v[154:155], v40 offset:13312
    ds_read_b64_tr_b16 v[156:157], v41 offset:12288
    ds_read_b64_tr_b16 v[158:159], v41 offset:13312
    s_waitcnt lgkmcnt(10)
    v_mfma_f32_32x32x16_bf16 v[160:175], v[136:139], v[100:103], v[160:175]
    v_mfma_f32_32x32x16_bf16 v[176:191], v[140:143], v[100:103], v[176:191]
    s_waitcnt lgkmcnt(5)
    v_mfma_f32_32x32x16_bf16 v[160:175], v[144:147], v[104:107], v[160:175]
    v_mfma_f32_32x32x16_bf16 v[176:191], v[148:151], v[104:107], v[176:191]
    s_waitcnt lgkmcnt(0)
    v_mfma_f32_32x32x16_bf16 v[160:175], v[152:155], v[108:111], v[160:175]
    v_mfma_f32_32x32x16_bf16 v[176:191], v[156:159], v[108:111], v[176:191]
    s_nop 7
    s_nop 7
    s_lshl_b32 s26, s22, 5
    v_and_b32 v32, 31, v1
    v_add_u32 v32, s26, v32
    v_lshlrev_b32 v32, 8, v32
    v_add_u32 v32, 131072, v32
    v_lshrrev_b32 v33, 5, v1
    v_lshl_add_u32 v32, v33, 3, v32
    v_and_b32 v33, 15, v1
    s_lshl_b32 s26, s23, 3
    v_cvt_pk_bf16_f32 v96, v160, v161
    v_cvt_pk_bf16_f32 v97, v162, v163
    s_add_u32 s27, s26, 0
    v_xor_b32 v34, s27, v33
    v_lshl_add_u32 v34, v34, 4, v32
    ds_write_b64 v34, v[96:97]
    v_cvt_pk_bf16_f32 v96, v164, v165
    v_cvt_pk_bf16_f32 v97, v166, v167
    s_add_u32 s27, s26, 1
    v_xor_b32 v34, s27, v33
    v_lshl_add_u32 v34, v34, 4, v32
    ds_write_b64 v34, v[96:97]
    v_cvt_pk_bf16_f32 v96, v168, v169
    v_cvt_pk_bf16_f32 v97, v170, v171
    s_add_u32 s27, s26, 2
    v_xor_b32 v34, s27, v33
    v_lshl_add_u32 v34, v34, 4, v32
    ds_write_b64 v34, v[96:97]
    v_cvt_pk_bf16_f32 v96, v172, v173
    v_cvt_pk_bf16_f32 v97, v174, v175
    s_add_u32 s27, s26, 3
    v_xor_b32 v34, s27, v33
    v_lshl_add_u32 v34, v34, 4, v32
    ds_write_b64 v34, v[96:97]
    v_cvt_pk_bf16_f32 v96, v176, v177
    v_cvt_pk_bf16_f32 v97, v178, v179
    s_add_u32 s27, s26, 4
    v_xor_b32 v34, s27, v33
    v_lshl_add_u32 v34, v34, 4, v32
    ds_write_b64 v34, v[96:97]
    v_cvt_pk_bf16_f32 v96, v180, v181
    v_cvt_pk_bf16_f32 v97, v182, v183
    s_add_u32 s27, s26, 5
    v_xor_b32 v34, s27, v33
    v_lshl_add_u32 v34, v34, 4, v32
    ds_write_b64 v34, v[96:97]
    v_cvt_pk_bf16_f32 v96, v184, v185
    v_cvt_pk_bf16_f32 v97, v186, v187
    s_add_u32 s27, s26, 6
    v_xor_b32 v34, s27, v33
    v_lshl_add_u32 v34, v34, 4, v32
    ds_write_b64 v34, v[96:97]
    v_cvt_pk_bf16_f32 v96, v188, v189
    v_cvt_pk_bf16_f32 v97, v190, v191
    s_add_u32 s27, s26, 7
    v_xor_b32 v34, s27, v33
    v_lshl_add_u32 v34, v34, 4, v32
    ds_write_b64 v34, v[96:97]
    s_waitcnt lgkmcnt(0)
    s_barrier
    v_lshrrev_b32 v34, 5, v1
    v_xor_b32 v34, v34, v33
    v_lshrrev_b32 v35, 5, v1
    v_lshlrev_b32 v35, 3, v35
    v_sub_u32 v35, v32, v35
    v_xor_b32 v36, 0, v34
    v_lshl_add_u32 v36, v36, 4, v35
    ds_read_b128 v[48:51], v36
    v_xor_b32 v36, 2, v34
    v_lshl_add_u32 v36, v36, 4, v35
    ds_read_b128 v[52:55], v36
    v_xor_b32 v36, 4, v34
    v_lshl_add_u32 v36, v36, 4, v35
    ds_read_b128 v[56:59], v36
    v_xor_b32 v36, 6, v34
    v_lshl_add_u32 v36, v36, 4, v35
    ds_read_b128 v[60:63], v36
    v_xor_b32 v36, 8, v34
    v_lshl_add_u32 v36, v36, 4, v35
    ds_read_b128 v[64:67], v36
    v_xor_b32 v36, 10, v34
    v_lshl_add_u32 v36, v36, 4, v35
    ds_read_b128 v[68:71], v36
    v_xor_b32 v36, 12, v34
    v_lshl_add_u32 v36, v36, 4, v35
    ds_read_b128 v[72:75], v36
    v_xor_b32 v36, 14, v34
    v_lshl_add_u32 v36, v36, 4, v35
    ds_read_b128 v[76:79], v36
    v_mov_b32 v160, 0
    v_mov_b32 v161, 0
    v_mov_b32 v162, 0
    v_mov_b32 v163, 0
    v_mov_b32 v164, 0
    v_mov_b32 v165, 0
    v_mov_b32 v166, 0
    v_mov_b32 v167, 0
    v_mov_b32 v168, 0
    v_mov_b32 v169, 0
    v_mov_b32 v170, 0
    v_mov_b32 v171, 0
    v_mov_b32 v172, 0
    v_mov_b32 v173, 0
    v_mov_b32 v174, 0
    v_mov_b32 v175, 0
    v_mov_b32 v176, 0
    v_mov_b32 v177, 0
    v_mov_b32 v178, 0
    v_mov_b32 v179, 0
    v_mov_b32 v180, 0
    v_mov_b32 v181, 0
    v_mov_b32 v182, 0
    v_mov_b32 v183, 0
    v_mov_b32 v184, 0
    v_mov_b32 v185, 0
    v_mov_b32 v186, 0
    v_mov_b32 v187, 0
    v_mov_b32 v188, 0
    v_mov_b32 v189, 0
    v_mov_b32 v190, 0
    v_mov_b32 v191, 0
    v_mov_b32 v192, 0
    v_mov_b32 v193, 0
    v_mov_b32 v194, 0
    v_mov_b32 v195, 0
    v_mov_b32 v196, 0
    v_mov_b32 v197, 0
    v_mov_b32 v198, 0
    v_mov_b32 v199, 0
    v_mov_b32 v200, 0
    v_mov_b32 v201, 0
    v_mov_b32 v202, 0
    v_mov_b32 v203, 0
    v_mov_b32 v204, 0
    v_mov_b32 v205, 0
    v_mov_b32 v206, 0
    v_mov_b32 v207, 0
    v_mov_b32 v208, 0
    v_mov_b32 v209, 0
    v_mov_b32 v210, 0
    v_mov_b32 v211, 0
    v_mov_b32 v212, 0
    v_mov_b32 v213, 0
    v_mov_b32 v214, 0
    v_mov_b32 v215, 0
    v_mov_b32 v216, 0
    v_mov_b32 v217, 0
    v_mov_b32 v218, 0
    v_mov_b32 v219, 0
    v_mov_b32 v220, 0
    v_mov_b32 v221, 0
    v_mov_b32 v222, 0
    v_mov_b32 v223, 0
    s_waitcnt lgkmcnt(0)
    s_waitcnt vmcnt(8)
    s_barrier
    s_add_u32 s25, s30, 0
    s_mov_b32 m0, s25
    s_add_u32 s26, s24, 0
    buffer_load_dwordx4 v2, s[4:7], s26 offen nt lds
    s_add_u32 s25, s30, 1024
    s_mov_b32 m0, s25
    s_add_u32 s26, s24, 1024
    buffer_load_dwordx4 v3, s[4:7], s26 offen nt lds
    s_add_u32 s25, s30, 16384
    s_mov_b32 m0, s25
    s_add_u32 s26, s24, 0
    buffer_load_dwordx4 v4, s[8:11], s26 offen nt lds
    s_add_u32 s25, s30, 17408
    s_mov_b32 m0, s25
    s_add_u32 s26, s24, 1024
    buffer_load_dwordx4 v4, s[8:11], s26 offen nt lds
    s_add_u32 s24, s24, 16384
    ds_read_b128 v[96:99], v5 offset:32768
    ds_read_b128 v[100:103], v6 offset:32768
    ds_read_b128 v[104:107], v7 offset:32768
    ds_read_b128 v[108:111], v8 offset:32768
    ds_read_b128 v[112:115], v9 offset:32768
    ds_read_b128 v[116:119], v10 offset:32768
    ds_read_b128 v[120:123], v11 offset:32768
    ds_read_b128 v[124:127], v12 offset:32768
    s_waitcnt lgkmcnt(7)
    v_mfma_f32_32x32x16_bf16 v[80:95], v[96:99], v[48:51], 0
    s_waitcnt lgkmcnt(6)
    v_mfma_f32_32x32x16_bf16 v[80:95], v[100:103], v[52:55], v[80:95]
    s_waitcnt lgkmcnt(5)
    v_mfma_f32_32x32x16_bf16 v[80:95], v[104:107], v[56:59], v[80:95]
    s_waitcnt lgkmcnt(4)
    v_mfma_f32_32x32x16_bf16 v[80:95], v[108:111], v[60:63], v[80:95]
    s_waitcnt lgkmcnt(3)
    v_mfma_f32_32x32x16_bf16 v[80:95], v[112:115], v[64:67], v[80:95]
    s_waitcnt lgkmcnt(2)
    v_mfma_f32_32x32x16_bf16 v[80:95], v[116:119], v[68:71], v[80:95]
    s_waitcnt lgkmcnt(1)
    v_mfma_f32_32x32x16_bf16 v[80:95], v[120:123], v[72:75], v[80:95]
    s_waitcnt lgkmcnt(0)
    v_mfma_f32_32x32x16_bf16 v[80:95], v[124:127], v[76:79], v[80:95]
    ds_read_b64_tr_b16 v[128:129], v13 offset:32768
    ds_read_b64_tr_b16 v[130:131], v13 offset:34816
    ds_read_b64_tr_b16 v[132:133], v14 offset:32768
    ds_read_b64_tr_b16 v[134:135], v14 offset:34816
    ds_read_b64_tr_b16 v[136:137], v15 offset:32768
    ds_read_b64_tr_b16 v[138:139], v15 offset:34816
    ds_read_b64_tr_b16 v[140:141], v16 offset:32768
    ds_read_b64_tr_b16 v[142:143], v16 offset:34816
    ds_read_b64_tr_b16 v[144:145], v13 offset:36864
    ds_read_b64_tr_b16 v[146:147], v13 offset:38912
    ds_read_b64_tr_b16 v[148:149], v14 offset:36864
    ds_read_b64_tr_b16 v[150:151], v14 offset:38912
    ds_read_b64_tr_b16 v[152:153], v15 offset:36864
    ds_read_b64_tr_b16 v[154:155], v15 offset:38912
    ds_read_b64_tr_b16 v[156:157], v16 offset:36864
    ds_read_b64_tr_b16 v[158:159], v16 offset:38912
    s_nop 7
    s_nop 3
    v_max3_f32 v32, v80, v81, v82
    v_max3_f32 v33, v83, v84, v85
    v_max3_f32 v34, v86, v87, v88
    v_max3_f32 v35, v89, v90, v91
    v_max3_f32 v36, v92, v93, v94
    v_max3_f32 v32, v32, v33, v34
    v_max3_f32 v35, v35, v36, v95
    v_max_f32 v32, v32, v35
    v_mov_b32 v33, v32
    s_nop 1
    v_permlane32_swap_b32 v32, v33
    v_max_f32 v32, v32, v33
    v_mul_f32 v32, s28, v32
    v_max_f32 v33, v29, v32
    v_sub_f32 v34, v33, v29
    v_cmp_gt_f32 vcc, v34, s32
    s_cmp_lg_u64 vcc, 0
    s_cbranch_scc0 attn_kernel_skip0
    v_sub_f32 v34, v29, v33
    v_exp_f32 v31, v34
    v_mov_b32 v29, v33
    v_mul_f32 v30, v30, v31
    v_mul_f32 v160, v160, v31
    v_mul_f32 v161, v161, v31
    v_mul_f32 v162, v162, v31
    v_mul_f32 v163, v163, v31
    v_mul_f32 v164, v164, v31
    v_mul_f32 v165, v165, v31
    v_mul_f32 v166, v166, v31
    v_mul_f32 v167, v167, v31
    v_mul_f32 v168, v168, v31
    v_mul_f32 v169, v169, v31
    v_mul_f32 v170, v170, v31
    v_mul_f32 v171, v171, v31
    v_mul_f32 v172, v172, v31
    v_mul_f32 v173, v173, v31
    v_mul_f32 v174, v174, v31
    v_mul_f32 v175, v175, v31
    v_mul_f32 v176, v176, v31
    v_mul_f32 v177, v177, v31
    v_mul_f32 v178, v178, v31
    v_mul_f32 v179, v179, v31
    v_mul_f32 v180, v180, v31
    v_mul_f32 v181, v181, v31
    v_mul_f32 v182, v182, v31
    v_mul_f32 v183, v183, v31
    v_mul_f32 v184, v184, v31
    v_mul_f32 v185, v185, v31
    v_mul_f32 v186, v186, v31
    v_mul_f32 v187, v187, v31
    v_mul_f32 v188, v188, v31
    v_mul_f32 v189, v189, v31
    v_mul_f32 v190, v190, v31
    v_mul_f32 v191, v191, v31
    v_mul_f32 v192, v192, v31
    v_mul_f32 v193, v193, v31
    v_mul_f32 v194, v194, v31
    v_mul_f32 v195, v195, v31
    v_mul_f32 v196, v196, v31
    v_mul_f32 v197, v197, v31
    v_mul_f32 v198, v198, v31
    v_mul_f32 v199, v199, v31
    v_mul_f32 v200, v200, v31
    v_mul_f32 v201, v201, v31
    v_mul_f32 v202, v202, v31
    v_mul_f32 v203, v203, v31
    v_mul_f32 v204, v204, v31
    v_mul_f32 v205, v205, v31
    v_mul_f32 v206, v206, v31
    v_mul_f32 v207, v207, v31
    v_mul_f32 v208, v208, v31
    v_mul_f32 v209, v209, v31
    v_mul_f32 v210, v210, v31
    v_mul_f32 v211, v211, v31
    v_mul_f32 v212, v212, v31
    v_mul_f32 v213, v213, v31
    v_mul_f32 v214, v214, v31
    v_mul_f32 v215, v215, v31
    v_mul_f32 v216, v216, v31
    v_mul_f32 v217, v217, v31
    v_mul_f32 v218, v218, v31
    v_mul_f32 v219, v219, v31
    v_mul_f32 v220, v220, v31
    v_mul_f32 v221, v221, v31
    v_mul_f32 v222, v222, v31
    v_mul_f32 v223, v223, v31
attn_kernel_skip0:
    v_fma_f32 v80, v80, s28, -v29
    v_fma_f32 v81, v81, s28, -v29
    v_fma_f32 v82, v82, s28, -v29
    v_fma_f32 v83, v83, s28, -v29
    v_fma_f32 v84, v84, s28, -v29
    v_fma_f32 v85, v85, s28, -v29
    v_fma_f32 v86, v86, s28, -v29
    v_fma_f32 v87, v87, s28, -v29
    v_fma_f32 v88, v88, s28, -v29
    v_fma_f32 v89, v89, s28, -v29
    v_fma_f32 v90, v90, s28, -v29
    v_fma_f32 v91, v91, s28, -v29
    v_fma_f32 v92, v92, s28, -v29
    v_fma_f32 v93, v93, s28, -v29
    v_fma_f32 v94, v94, s28, -v29
    v_fma_f32 v95, v95, s28, -v29
    v_exp_f32 v80, v80
    v_exp_f32 v81, v81
    v_exp_f32 v82, v82
    v_exp_f32 v83, v83
    v_exp_f32 v84, v84
    v_exp_f32 v85, v85
    v_exp_f32 v86, v86
    v_exp_f32 v87, v87
    v_exp_f32 v88, v88
    v_exp_f32 v89, v89
    v_exp_f32 v90, v90
    v_exp_f32 v91, v91
    v_exp_f32 v92, v92
    v_exp_f32 v93, v93
    v_exp_f32 v94, v94
    v_exp_f32 v95, v95
    v_add_f32 v34, v80, v81
    v_add_f32 v30, v30, v34
    v_add_f32 v34, v82, v83
    v_add_f32 v30, v30, v34
    v_add_f32 v34, v84, v85
    v_add_f32 v30, v30, v34
    v_add_f32 v34, v86, v87
    v_add_f32 v30, v30, v34
    v_add_f32 v34, v88, v89
    v_add_f32 v30, v30, v34
    v_add_f32 v34, v90, v91
    v_add_f32 v30, v30, v34
    v_add_f32 v34, v92, v93
    v_add_f32 v30, v30, v34
    v_add_f32 v34, v94, v95
    v_add_f32 v30, v30, v34
    v_cvt_pk_bf16_f32 v40, v80, v81
    v_cvt_pk_bf16_f32 v41, v82, v83
    v_cvt_pk_bf16_f32 v42, v84, v85
    v_cvt_pk_bf16_f32 v43, v86, v87
    v_cvt_pk_bf16_f32 v44, v88, v89
    v_cvt_pk_bf16_f32 v45, v90, v91
    v_cvt_pk_bf16_f32 v46, v92, v93
    v_cvt_pk_bf16_f32 v47, v94, v95
    s_nop 1
    s_waitcnt lgkmcnt(14)
    v_mfma_f32_32x32x16_bf16 v[160:175], v[128:131], v[40:43], v[160:175]
    s_waitcnt lgkmcnt(12)
    v_mfma_f32_32x32x16_bf16 v[176:191], v[132:135], v[40:43], v[176:191]
    s_waitcnt lgkmcnt(10)
    v_mfma_f32_32x32x16_bf16 v[192:207], v[136:139], v[40:43], v[192:207]
    s_waitcnt lgkmcnt(8)
    v_mfma_f32_32x32x16_bf16 v[208:223], v[140:143], v[40:43], v[208:223]
    s_waitcnt lgkmcnt(6)
    v_mfma_f32_32x32x16_bf16 v[160:175], v[144:147], v[44:47], v[160:175]
    s_waitcnt lgkmcnt(4)
    v_mfma_f32_32x32x16_bf16 v[176:191], v[148:151], v[44:47], v[176:191]
    s_waitcnt lgkmcnt(2)
    v_mfma_f32_32x32x16_bf16 v[192:207], v[152:155], v[44:47], v[192:207]
    s_waitcnt lgkmcnt(0)
    v_mfma_f32_32x32x16_bf16 v[208:223], v[156:159], v[44:47], v[208:223]
    s_waitcnt vmcnt(8)
    s_barrier
    s_add_u32 s25, s30, 32768
    s_mov_b32 m0, s25
    s_add_u32 s26, s24, 0
    buffer_load_dwordx4 v2, s[4:7], s26 offen nt lds
    s_add_u32 s25, s30, 33792
    s_mov_b32 m0, s25
    s_add_u32 s26, s24, 1024
    buffer_load_dwordx4 v3, s[4:7], s26 offen nt lds
    s_add_u32 s25, s30, 49152
    s_mov_b32 m0, s25
    s_add_u32 s26, s24, 0
    buffer_load_dwordx4 v4, s[8:11], s26 offen nt lds
    s_add_u32 s25, s30, 50176
    s_mov_b32 m0, s25
    s_add_u32 s26, s24, 1024
    buffer_load_dwordx4 v4, s[8:11], s26 offen nt lds
    s_add_u32 s24, s24, 16384
    ds_read_b128 v[96:99], v17 offset:0
    ds_read_b128 v[100:103], v18 offset:0
    ds_read_b128 v[104:107], v19 offset:0
    ds_read_b128 v[108:111], v20 offset:0
    ds_read_b128 v[112:115], v21 offset:0
    ds_read_b128 v[116:119], v22 offset:0
    ds_read_b128 v[120:123], v23 offset:0
    ds_read_b128 v[124:127], v24 offset:0
    s_waitcnt lgkmcnt(7)
    v_mfma_f32_32x32x16_bf16 v[80:95], v[96:99], v[48:51], 0
    s_waitcnt lgkmcnt(6)
    v_mfma_f32_32x32x16_bf16 v[80:95], v[100:103], v[52:55], v[80:95]
    s_waitcnt lgkmcnt(5)
    v_mfma_f32_32x32x16_bf16 v[80:95], v[104:107], v[56:59], v[80:95]
    s_waitcnt lgkmcnt(4)
    v_mfma_f32_32x32x16_bf16 v[80:95], v[108:111], v[60:63], v[80:95]
    s_waitcnt lgkmcnt(3)
    v_mfma_f32_32x32x16_bf16 v[80:95], v[112:115], v[64:67], v[80:95]
    s_waitcnt lgkmcnt(2)
    v_mfma_f32_32x32x16_bf16 v[80:95], v[116:119], v[68:71], v[80:95]
    s_waitcnt lgkmcnt(1)
    v_mfma_f32_32x32x16_bf16 v[80:95], v[120:123], v[72:75], v[80:95]
    s_waitcnt lgkmcnt(0)
    v_mfma_f32_32x32x16_bf16 v[80:95], v[124:127], v[76:79], v[80:95]
    ds_read_b64_tr_b16 v[128:129], v25 offset:0
    ds_read_b64_tr_b16 v[130:131], v25 offset:2048
    ds_read_b64_tr_b16 v[132:133], v26 offset:0
    ds_read_b64_tr_b16 v[134:135], v26 offset:2048
    ds_read_b64_tr_b16 v[136:137], v27 offset:0
    ds_read_b64_tr_b16 v[138:139], v27 offset:2048
    ds_read_b64_tr_b16 v[140:141], v28 offset:0
    ds_read_b64_tr_b16 v[142:143], v28 offset:2048
    ds_read_b64_tr_b16 v[144:145], v25 offset:4096
    ds_read_b64_tr_b16 v[146:147], v25 offset:6144
    ds_read_b64_tr_b16 v[148:149], v26 offset:4096
    ds_read_b64_tr_b16 v[150:151], v26 offset:6144
    ds_read_b64_tr_b16 v[152:153], v27 offset:4096
    ds_read_b64_tr_b16 v[154:155], v27 offset:6144
    ds_read_b64_tr_b16 v[156:157], v28 offset:4096
    ds_read_b64_tr_b16 v[158:159], v28 offset:6144
    s_nop 7
    s_nop 3
    v_max3_f32 v32, v80, v81, v82
    v_max3_f32 v33, v83, v84, v85
    v_max3_f32 v34, v86, v87, v88
    v_max3_f32 v35, v89, v90, v91
    v_max3_f32 v36, v92, v93, v94
    v_max3_f32 v32, v32, v33, v34
    v_max3_f32 v35, v35, v36, v95
    v_max_f32 v32, v32, v35
    v_mov_b32 v33, v32
    s_nop 1
    v_permlane32_swap_b32 v32, v33
    v_max_f32 v32, v32, v33
    v_mul_f32 v32, s28, v32
    v_max_f32 v33, v29, v32
    v_sub_f32 v34, v33, v29
    v_cmp_gt_f32 vcc, v34, s32
    s_cmp_lg_u64 vcc, 0
    s_cbranch_scc0 attn_kernel_skip1
    v_sub_f32 v34, v29, v33
    v_exp_f32 v31, v34
    v_mov_b32 v29, v33
    v_mul_f32 v30, v30, v31
    v_mul_f32 v160, v160, v31
    v_mul_f32 v161, v161, v31
    v_mul_f32 v162, v162, v31
    v_mul_f32 v163, v163, v31
    v_mul_f32 v164, v164, v31
    v_mul_f32 v165, v165, v31
    v_mul_f32 v166, v166, v31
    v_mul_f32 v167, v167, v31
    v_mul_f32 v168, v168, v31
    v_mul_f32 v169, v169, v31
    v_mul_f32 v170, v170, v31
    v_mul_f32 v171, v171, v31
    v_mul_f32 v172, v172, v31
    v_mul_f32 v173, v173, v31
    v_mul_f32 v174, v174, v31
    v_mul_f32 v175, v175, v31
    v_mul_f32 v176, v176, v31
    v_mul_f32 v177, v177, v31
    v_mul_f32 v178, v178, v31
    v_mul_f32 v179, v179, v31
    v_mul_f32 v180, v180, v31
    v_mul_f32 v181, v181, v31
    v_mul_f32 v182, v182, v31
    v_mul_f32 v183, v183, v31
    v_mul_f32 v184, v184, v31
    v_mul_f32 v185, v185, v31
    v_mul_f32 v186, v186, v31
    v_mul_f32 v187, v187, v31
    v_mul_f32 v188, v188, v31
    v_mul_f32 v189, v189, v31
    v_mul_f32 v190, v190, v31
    v_mul_f32 v191, v191, v31
    v_mul_f32 v192, v192, v31
    v_mul_f32 v193, v193, v31
    v_mul_f32 v194, v194, v31
    v_mul_f32 v195, v195, v31
    v_mul_f32 v196, v196, v31
    v_mul_f32 v197, v197, v31
    v_mul_f32 v198, v198, v31
    v_mul_f32 v199, v199, v31
    v_mul_f32 v200, v200, v31
    v_mul_f32 v201, v201, v31
    v_mul_f32 v202, v202, v31
    v_mul_f32 v203, v203, v31
    v_mul_f32 v204, v204, v31
    v_mul_f32 v205, v205, v31
    v_mul_f32 v206, v206, v31
    v_mul_f32 v207, v207, v31
    v_mul_f32 v208, v208, v31
    v_mul_f32 v209, v209, v31
    v_mul_f32 v210, v210, v31
    v_mul_f32 v211, v211, v31
    v_mul_f32 v212, v212, v31
    v_mul_f32 v213, v213, v31
    v_mul_f32 v214, v214, v31
    v_mul_f32 v215, v215, v31
    v_mul_f32 v216, v216, v31
    v_mul_f32 v217, v217, v31
    v_mul_f32 v218, v218, v31
    v_mul_f32 v219, v219, v31
    v_mul_f32 v220, v220, v31
    v_mul_f32 v221, v221, v31
    v_mul_f32 v222, v222, v31
    v_mul_f32 v223, v223, v31
attn_kernel_skip1:
    v_fma_f32 v80, v80, s28, -v29
    v_fma_f32 v81, v81, s28, -v29
    v_fma_f32 v82, v82, s28, -v29
    v_fma_f32 v83, v83, s28, -v29
    v_fma_f32 v84, v84, s28, -v29
    v_fma_f32 v85, v85, s28, -v29
    v_fma_f32 v86, v86, s28, -v29
    v_fma_f32 v87, v87, s28, -v29
    v_fma_f32 v88, v88, s28, -v29
    v_fma_f32 v89, v89, s28, -v29
    v_fma_f32 v90, v90, s28, -v29
    v_fma_f32 v91, v91, s28, -v29
    v_fma_f32 v92, v92, s28, -v29
    v_fma_f32 v93, v93, s28, -v29
    v_fma_f32 v94, v94, s28, -v29
    v_fma_f32 v95, v95, s28, -v29
    v_exp_f32 v80, v80
    v_exp_f32 v81, v81
    v_exp_f32 v82, v82
    v_exp_f32 v83, v83
    v_exp_f32 v84, v84
    v_exp_f32 v85, v85
    v_exp_f32 v86, v86
    v_exp_f32 v87, v87
    v_exp_f32 v88, v88
    v_exp_f32 v89, v89
    v_exp_f32 v90, v90
    v_exp_f32 v91, v91
    v_exp_f32 v92, v92
    v_exp_f32 v93, v93
    v_exp_f32 v94, v94
    v_exp_f32 v95, v95
    v_add_f32 v34, v80, v81
    v_add_f32 v30, v30, v34
    v_add_f32 v34, v82, v83
    v_add_f32 v30, v30, v34
    v_add_f32 v34, v84, v85
    v_add_f32 v30, v30, v34
    v_add_f32 v34, v86, v87
    v_add_f32 v30, v30, v34
    v_add_f32 v34, v88, v89
    v_add_f32 v30, v30, v34
    v_add_f32 v34, v90, v91
    v_add_f32 v30, v30, v34
    v_add_f32 v34, v92, v93
    v_add_f32 v30, v30, v34
    v_add_f32 v34, v94, v95
    v_add_f32 v30, v30, v34
    v_cvt_pk_bf16_f32 v40, v80, v81
    v_cvt_pk_bf16_f32 v41, v82, v83
    v_cvt_pk_bf16_f32 v42, v84, v85
    v_cvt_pk_bf16_f32 v43, v86, v87
    v_cvt_pk_bf16_f32 v44, v88, v89
    v_cvt_pk_bf16_f32 v45, v90, v91
    v_cvt_pk_bf16_f32 v46, v92, v93
    v_cvt_pk_bf16_f32 v47, v94, v95
    s_nop 1
    s_waitcnt lgkmcnt(14)
    v_mfma_f32_32x32x16_bf16 v[160:175], v[128:131], v[40:43], v[160:175]
    s_waitcnt lgkmcnt(12)
    v_mfma_f32_32x32x16_bf16 v[176:191], v[132:135], v[40:43], v[176:191]
    s_waitcnt lgkmcnt(10)
    v_mfma_f32_32x32x16_bf16 v[192:207], v[136:139], v[40:43], v[192:207]
    s_waitcnt lgkmcnt(8)
    v_mfma_f32_32x32x16_bf16 v[208:223], v[140:143], v[40:43], v[208:223]
    s_waitcnt lgkmcnt(6)
    v_mfma_f32_32x32x16_bf16 v[160:175], v[144:147], v[44:47], v[160:175]
    s_waitcnt lgkmcnt(4)
    v_mfma_f32_32x32x16_bf16 v[176:191], v[148:151], v[44:47], v[176:191]
    s_waitcnt lgkmcnt(2)
    v_mfma_f32_32x32x16_bf16 v[192:207], v[152:155], v[44:47], v[192:207]
    s_waitcnt lgkmcnt(0)
    v_mfma_f32_32x32x16_bf16 v[208:223], v[156:159], v[44:47], v[208:223]
    s_waitcnt vmcnt(8)
    s_barrier
    s_add_u32 s25, s30, 65536
    s_mov_b32 m0, s25
    s_add_u32 s26, s24, 0
    buffer_load_dwordx4 v2, s[4:7], s26 offen nt lds
    s_add_u32 s25, s30, 66560
    s_mov_b32 m0, s25
    s_add_u32 s26, s24, 1024
    buffer_load_dwordx4 v3, s[4:7], s26 offen nt lds
    s_add_u32 s25, s30, 81920
    s_mov_b32 m0, s25
    s_add_u32 s26, s24, 0
    buffer_load_dwordx4 v4, s[8:11], s26 offen nt lds
    s_add_u32 s25, s30, 82944
    s_mov_b32 m0, s25
    s_add_u32 s26, s24, 1024
    buffer_load_dwordx4 v4, s[8:11], s26 offen nt lds
    s_add_u32 s24, s24, 16384
    ds_read_b128 v[96:99], v17 offset:32768
    ds_read_b128 v[100:103], v18 offset:32768
    ds_read_b128 v[104:107], v19 offset:32768
    ds_read_b128 v[108:111], v20 offset:32768
    ds_read_b128 v[112:115], v21 offset:32768
    ds_read_b128 v[116:119], v22 offset:32768
    ds_read_b128 v[120:123], v23 offset:32768
    ds_read_b128 v[124:127], v24 offset:32768
    s_waitcnt lgkmcnt(7)
    v_mfma_f32_32x32x16_bf16 v[80:95], v[96:99], v[48:51], 0
    s_waitcnt lgkmcnt(6)
    v_mfma_f32_32x32x16_bf16 v[80:95], v[100:103], v[52:55], v[80:95]
    s_waitcnt lgkmcnt(5)
    v_mfma_f32_32x32x16_bf16 v[80:95], v[104:107], v[56:59], v[80:95]
    s_waitcnt lgkmcnt(4)
    v_mfma_f32_32x32x16_bf16 v[80:95], v[108:111], v[60:63], v[80:95]
    s_waitcnt lgkmcnt(3)
    v_mfma_f32_32x32x16_bf16 v[80:95], v[112:115], v[64:67], v[80:95]
    s_waitcnt lgkmcnt(2)
    v_mfma_f32_32x32x16_bf16 v[80:95], v[116:119], v[68:71], v[80:95]
    s_waitcnt lgkmcnt(1)
    v_mfma_f32_32x32x16_bf16 v[80:95], v[120:123], v[72:75], v[80:95]
    s_waitcnt lgkmcnt(0)
    v_mfma_f32_32x32x16_bf16 v[80:95], v[124:127], v[76:79], v[80:95]
    ds_read_b64_tr_b16 v[128:129], v25 offset:32768
    ds_read_b64_tr_b16 v[130:131], v25 offset:34816
    ds_read_b64_tr_b16 v[132:133], v26 offset:32768
    ds_read_b64_tr_b16 v[134:135], v26 offset:34816
    ds_read_b64_tr_b16 v[136:137], v27 offset:32768
    ds_read_b64_tr_b16 v[138:139], v27 offset:34816
    ds_read_b64_tr_b16 v[140:141], v28 offset:32768
    ds_read_b64_tr_b16 v[142:143], v28 offset:34816
    ds_read_b64_tr_b16 v[144:145], v25 offset:36864
    ds_read_b64_tr_b16 v[146:147], v25 offset:38912
    ds_read_b64_tr_b16 v[148:149], v26 offset:36864
    ds_read_b64_tr_b16 v[150:151], v26 offset:38912
    ds_read_b64_tr_b16 v[152:153], v27 offset:36864
    ds_read_b64_tr_b16 v[154:155], v27 offset:38912
    ds_read_b64_tr_b16 v[156:157], v28 offset:36864
    ds_read_b64_tr_b16 v[158:159], v28 offset:38912
    s_nop 7
    s_nop 3
    v_max3_f32 v32, v80, v81, v82
    v_max3_f32 v33, v83, v84, v85
    v_max3_f32 v34, v86, v87, v88
    v_max3_f32 v35, v89, v90, v91
    v_max3_f32 v36, v92, v93, v94
    v_max3_f32 v32, v32, v33, v34
    v_max3_f32 v35, v35, v36, v95
    v_max_f32 v32, v32, v35
    v_mov_b32 v33, v32
    s_nop 1
    v_permlane32_swap_b32 v32, v33
    v_max_f32 v32, v32, v33
    v_mul_f32 v32, s28, v32
    v_max_f32 v33, v29, v32
    v_sub_f32 v34, v33, v29
    v_cmp_gt_f32 vcc, v34, s32
    s_cmp_lg_u64 vcc, 0
    s_cbranch_scc0 attn_kernel_skip2
    v_sub_f32 v34, v29, v33
    v_exp_f32 v31, v34
    v_mov_b32 v29, v33
    v_mul_f32 v30, v30, v31
    v_mul_f32 v160, v160, v31
    v_mul_f32 v161, v161, v31
    v_mul_f32 v162, v162, v31
    v_mul_f32 v163, v163, v31
    v_mul_f32 v164, v164, v31
    v_mul_f32 v165, v165, v31
    v_mul_f32 v166, v166, v31
    v_mul_f32 v167, v167, v31
    v_mul_f32 v168, v168, v31
    v_mul_f32 v169, v169, v31
    v_mul_f32 v170, v170, v31
    v_mul_f32 v171, v171, v31
    v_mul_f32 v172, v172, v31
    v_mul_f32 v173, v173, v31
    v_mul_f32 v174, v174, v31
    v_mul_f32 v175, v175, v31
    v_mul_f32 v176, v176, v31
    v_mul_f32 v177, v177, v31
    v_mul_f32 v178, v178, v31
    v_mul_f32 v179, v179, v31
    v_mul_f32 v180, v180, v31
    v_mul_f32 v181, v181, v31
    v_mul_f32 v182, v182, v31
    v_mul_f32 v183, v183, v31
    v_mul_f32 v184, v184, v31
    v_mul_f32 v185, v185, v31
    v_mul_f32 v186, v186, v31
    v_mul_f32 v187, v187, v31
    v_mul_f32 v188, v188, v31
    v_mul_f32 v189, v189, v31
    v_mul_f32 v190, v190, v31
    v_mul_f32 v191, v191, v31
    v_mul_f32 v192, v192, v31
    v_mul_f32 v193, v193, v31
    v_mul_f32 v194, v194, v31
    v_mul_f32 v195, v195, v31
    v_mul_f32 v196, v196, v31
    v_mul_f32 v197, v197, v31
    v_mul_f32 v198, v198, v31
    v_mul_f32 v199, v199, v31
    v_mul_f32 v200, v200, v31
    v_mul_f32 v201, v201, v31
    v_mul_f32 v202, v202, v31
    v_mul_f32 v203, v203, v31
    v_mul_f32 v204, v204, v31
    v_mul_f32 v205, v205, v31
    v_mul_f32 v206, v206, v31
    v_mul_f32 v207, v207, v31
    v_mul_f32 v208, v208, v31
    v_mul_f32 v209, v209, v31
    v_mul_f32 v210, v210, v31
    v_mul_f32 v211, v211, v31
    v_mul_f32 v212, v212, v31
    v_mul_f32 v213, v213, v31
    v_mul_f32 v214, v214, v31
    v_mul_f32 v215, v215, v31
    v_mul_f32 v216, v216, v31
    v_mul_f32 v217, v217, v31
    v_mul_f32 v218, v218, v31
    v_mul_f32 v219, v219, v31
    v_mul_f32 v220, v220, v31
    v_mul_f32 v221, v221, v31
    v_mul_f32 v222, v222, v31
    v_mul_f32 v223, v223, v31
attn_kernel_skip2:
    v_fma_f32 v80, v80, s28, -v29
    v_fma_f32 v81, v81, s28, -v29
    v_fma_f32 v82, v82, s28, -v29
    v_fma_f32 v83, v83, s28, -v29
    v_fma_f32 v84, v84, s28, -v29
    v_fma_f32 v85, v85, s28, -v29
    v_fma_f32 v86, v86, s28, -v29
    v_fma_f32 v87, v87, s28, -v29
    v_fma_f32 v88, v88, s28, -v29
    v_fma_f32 v89, v89, s28, -v29
    v_fma_f32 v90, v90, s28, -v29
    v_fma_f32 v91, v91, s28, -v29
    v_fma_f32 v92, v92, s28, -v29
    v_fma_f32 v93, v93, s28, -v29
    v_fma_f32 v94, v94, s28, -v29
    v_fma_f32 v95, v95, s28, -v29
    v_exp_f32 v80, v80
    v_exp_f32 v81, v81
    v_exp_f32 v82, v82
    v_exp_f32 v83, v83
    v_exp_f32 v84, v84
    v_exp_f32 v85, v85
    v_exp_f32 v86, v86
    v_exp_f32 v87, v87
    v_exp_f32 v88, v88
    v_exp_f32 v89, v89
    v_exp_f32 v90, v90
    v_exp_f32 v91, v91
    v_exp_f32 v92, v92
    v_exp_f32 v93, v93
    v_exp_f32 v94, v94
    v_exp_f32 v95, v95
    v_add_f32 v34, v80, v81
    v_add_f32 v30, v30, v34
    v_add_f32 v34, v82, v83
    v_add_f32 v30, v30, v34
    v_add_f32 v34, v84, v85
    v_add_f32 v30, v30, v34
    v_add_f32 v34, v86, v87
    v_add_f32 v30, v30, v34
    v_add_f32 v34, v88, v89
    v_add_f32 v30, v30, v34
    v_add_f32 v34, v90, v91
    v_add_f32 v30, v30, v34
    v_add_f32 v34, v92, v93
    v_add_f32 v30, v30, v34
    v_add_f32 v34, v94, v95
    v_add_f32 v30, v30, v34
    v_cvt_pk_bf16_f32 v40, v80, v81
    v_cvt_pk_bf16_f32 v41, v82, v83
    v_cvt_pk_bf16_f32 v42, v84, v85
    v_cvt_pk_bf16_f32 v43, v86, v87
    v_cvt_pk_bf16_f32 v44, v88, v89
    v_cvt_pk_bf16_f32 v45, v90, v91
    v_cvt_pk_bf16_f32 v46, v92, v93
    v_cvt_pk_bf16_f32 v47, v94, v95
    s_nop 1
    s_waitcnt lgkmcnt(14)
    v_mfma_f32_32x32x16_bf16 v[160:175], v[128:131], v[40:43], v[160:175]
    s_waitcnt lgkmcnt(12)
    v_mfma_f32_32x32x16_bf16 v[176:191], v[132:135], v[40:43], v[176:191]
    s_waitcnt lgkmcnt(10)
    v_mfma_f32_32x32x16_bf16 v[192:207], v[136:139], v[40:43], v[192:207]
    s_waitcnt lgkmcnt(8)
    v_mfma_f32_32x32x16_bf16 v[208:223], v[140:143], v[40:43], v[208:223]
    s_waitcnt lgkmcnt(6)
    v_mfma_f32_32x32x16_bf16 v[160:175], v[144:147], v[44:47], v[160:175]
    s_waitcnt lgkmcnt(4)
    v_mfma_f32_32x32x16_bf16 v[176:191], v[148:151], v[44:47], v[176:191]
    s_waitcnt lgkmcnt(2)
    v_mfma_f32_32x32x16_bf16 v[192:207], v[152:155], v[44:47], v[192:207]
    s_waitcnt lgkmcnt(0)
    v_mfma_f32_32x32x16_bf16 v[208:223], v[156:159], v[44:47], v[208:223]
    s_waitcnt vmcnt(8)
    s_barrier
    s_add_u32 s25, s30, 98304
    s_mov_b32 m0, s25
    s_add_u32 s26, s24, 0
    buffer_load_dwordx4 v2, s[4:7], s26 offen nt lds
    s_add_u32 s25, s30, 99328
    s_mov_b32 m0, s25
    s_add_u32 s26, s24, 1024
    buffer_load_dwordx4 v3, s[4:7], s26 offen nt lds
    s_add_u32 s25, s30, 114688
    s_mov_b32 m0, s25
    s_add_u32 s26, s24, 0
    buffer_load_dwordx4 v4, s[8:11], s26 offen nt lds
    s_add_u32 s25, s30, 115712
    s_mov_b32 m0, s25
    s_add_u32 s26, s24, 1024
    buffer_load_dwordx4 v4, s[8:11], s26 offen nt lds
    s_add_u32 s24, s24, 16384
    ds_read_b128 v[96:99], v5 offset:0
    ds_read_b128 v[100:103], v6 offset:0
    ds_read_b128 v[104:107], v7 offset:0
    ds_read_b128 v[108:111], v8 offset:0
    ds_read_b128 v[112:115], v9 offset:0
    ds_read_b128 v[116:119], v10 offset:0
    ds_read_b128 v[120:123], v11 offset:0
    ds_read_b128 v[124:127], v12 offset:0
    s_waitcnt lgkmcnt(7)
    v_mfma_f32_32x32x16_bf16 v[80:95], v[96:99], v[48:51], 0
    s_waitcnt lgkmcnt(6)
    v_mfma_f32_32x32x16_bf16 v[80:95], v[100:103], v[52:55], v[80:95]
    s_waitcnt lgkmcnt(5)
    v_mfma_f32_32x32x16_bf16 v[80:95], v[104:107], v[56:59], v[80:95]
    s_waitcnt lgkmcnt(4)
    v_mfma_f32_32x32x16_bf16 v[80:95], v[108:111], v[60:63], v[80:95]
    s_waitcnt lgkmcnt(3)
    v_mfma_f32_32x32x16_bf16 v[80:95], v[112:115], v[64:67], v[80:95]
    s_waitcnt lgkmcnt(2)
    v_mfma_f32_32x32x16_bf16 v[80:95], v[116:119], v[68:71], v[80:95]
    s_waitcnt lgkmcnt(1)
    v_mfma_f32_32x32x16_bf16 v[80:95], v[120:123], v[72:75], v[80:95]
    s_waitcnt lgkmcnt(0)
    v_mfma_f32_32x32x16_bf16 v[80:95], v[124:127], v[76:79], v[80:95]
    ds_read_b64_tr_b16 v[128:129], v13 offset:0
    ds_read_b64_tr_b16 v[130:131], v13 offset:2048
    ds_read_b64_tr_b16 v[132:133], v14 offset:0
    ds_read_b64_tr_b16 v[134:135], v14 offset:2048
    ds_read_b64_tr_b16 v[136:137], v15 offset:0
    ds_read_b64_tr_b16 v[138:139], v15 offset:2048
    ds_read_b64_tr_b16 v[140:141], v16 offset:0
    ds_read_b64_tr_b16 v[142:143], v16 offset:2048
    ds_read_b64_tr_b16 v[144:145], v13 offset:4096
    ds_read_b64_tr_b16 v[146:147], v13 offset:6144
    ds_read_b64_tr_b16 v[148:149], v14 offset:4096
    ds_read_b64_tr_b16 v[150:151], v14 offset:6144
    ds_read_b64_tr_b16 v[152:153], v15 offset:4096
    ds_read_b64_tr_b16 v[154:155], v15 offset:6144
    ds_read_b64_tr_b16 v[156:157], v16 offset:4096
    ds_read_b64_tr_b16 v[158:159], v16 offset:6144
    s_nop 7
    s_nop 3
    v_max3_f32 v32, v80, v81, v82
    v_max3_f32 v33, v83, v84, v85
    v_max3_f32 v34, v86, v87, v88
    v_max3_f32 v35, v89, v90, v91
    v_max3_f32 v36, v92, v93, v94
    v_max3_f32 v32, v32, v33, v34
    v_max3_f32 v35, v35, v36, v95
    v_max_f32 v32, v32, v35
    v_mov_b32 v33, v32
    s_nop 1
    v_permlane32_swap_b32 v32, v33
    v_max_f32 v32, v32, v33
    v_mul_f32 v32, s28, v32
    v_max_f32 v33, v29, v32
    v_sub_f32 v34, v33, v29
    v_cmp_gt_f32 vcc, v34, s32
    s_cmp_lg_u64 vcc, 0
    s_cbranch_scc0 attn_kernel_skip3
    v_sub_f32 v34, v29, v33
    v_exp_f32 v31, v34
    v_mov_b32 v29, v33
    v_mul_f32 v30, v30, v31
    v_mul_f32 v160, v160, v31
    v_mul_f32 v161, v161, v31
    v_mul_f32 v162, v162, v31
    v_mul_f32 v163, v163, v31
    v_mul_f32 v164, v164, v31
    v_mul_f32 v165, v165, v31
    v_mul_f32 v166, v166, v31
    v_mul_f32 v167, v167, v31
    v_mul_f32 v168, v168, v31
    v_mul_f32 v169, v169, v31
    v_mul_f32 v170, v170, v31
    v_mul_f32 v171, v171, v31
    v_mul_f32 v172, v172, v31
    v_mul_f32 v173, v173, v31
    v_mul_f32 v174, v174, v31
    v_mul_f32 v175, v175, v31
    v_mul_f32 v176, v176, v31
    v_mul_f32 v177, v177, v31
    v_mul_f32 v178, v178, v31
    v_mul_f32 v179, v179, v31
    v_mul_f32 v180, v180, v31
    v_mul_f32 v181, v181, v31
    v_mul_f32 v182, v182, v31
    v_mul_f32 v183, v183, v31
    v_mul_f32 v184, v184, v31
    v_mul_f32 v185, v185, v31
    v_mul_f32 v186, v186, v31
    v_mul_f32 v187, v187, v31
    v_mul_f32 v188, v188, v31
    v_mul_f32 v189, v189, v31
    v_mul_f32 v190, v190, v31
    v_mul_f32 v191, v191, v31
    v_mul_f32 v192, v192, v31
    v_mul_f32 v193, v193, v31
    v_mul_f32 v194, v194, v31
    v_mul_f32 v195, v195, v31
    v_mul_f32 v196, v196, v31
    v_mul_f32 v197, v197, v31
    v_mul_f32 v198, v198, v31
    v_mul_f32 v199, v199, v31
    v_mul_f32 v200, v200, v31
    v_mul_f32 v201, v201, v31
    v_mul_f32 v202, v202, v31
    v_mul_f32 v203, v203, v31
    v_mul_f32 v204, v204, v31
    v_mul_f32 v205, v205, v31
    v_mul_f32 v206, v206, v31
    v_mul_f32 v207, v207, v31
    v_mul_f32 v208, v208, v31
    v_mul_f32 v209, v209, v31
    v_mul_f32 v210, v210, v31
    v_mul_f32 v211, v211, v31
    v_mul_f32 v212, v212, v31
    v_mul_f32 v213, v213, v31
    v_mul_f32 v214, v214, v31
    v_mul_f32 v215, v215, v31
    v_mul_f32 v216, v216, v31
    v_mul_f32 v217, v217, v31
    v_mul_f32 v218, v218, v31
    v_mul_f32 v219, v219, v31
    v_mul_f32 v220, v220, v31
    v_mul_f32 v221, v221, v31
    v_mul_f32 v222, v222, v31
    v_mul_f32 v223, v223, v31
attn_kernel_skip3:
    v_fma_f32 v80, v80, s28, -v29
    v_fma_f32 v81, v81, s28, -v29
    v_fma_f32 v82, v82, s28, -v29
    v_fma_f32 v83, v83, s28, -v29
    v_fma_f32 v84, v84, s28, -v29
    v_fma_f32 v85, v85, s28, -v29
    v_fma_f32 v86, v86, s28, -v29
    v_fma_f32 v87, v87, s28, -v29
    v_fma_f32 v88, v88, s28, -v29
    v_fma_f32 v89, v89, s28, -v29
    v_fma_f32 v90, v90, s28, -v29
    v_fma_f32 v91, v91, s28, -v29
    v_fma_f32 v92, v92, s28, -v29
    v_fma_f32 v93, v93, s28, -v29
    v_fma_f32 v94, v94, s28, -v29
    v_fma_f32 v95, v95, s28, -v29
    v_exp_f32 v80, v80
    v_exp_f32 v81, v81
    v_exp_f32 v82, v82
    v_exp_f32 v83, v83
    v_exp_f32 v84, v84
    v_exp_f32 v85, v85
    v_exp_f32 v86, v86
    v_exp_f32 v87, v87
    v_exp_f32 v88, v88
    v_exp_f32 v89, v89
    v_exp_f32 v90, v90
    v_exp_f32 v91, v91
    v_exp_f32 v92, v92
    v_exp_f32 v93, v93
    v_exp_f32 v94, v94
    v_exp_f32 v95, v95
    v_add_f32 v34, v80, v81
    v_add_f32 v30, v30, v34
    v_add_f32 v34, v82, v83
    v_add_f32 v30, v30, v34
    v_add_f32 v34, v84, v85
    v_add_f32 v30, v30, v34
    v_add_f32 v34, v86, v87
    v_add_f32 v30, v30, v34
    v_add_f32 v34, v88, v89
    v_add_f32 v30, v30, v34
    v_add_f32 v34, v90, v91
    v_add_f32 v30, v30, v34
    v_add_f32 v34, v92, v93
    v_add_f32 v30, v30, v34
    v_add_f32 v34, v94, v95
    v_add_f32 v30, v30, v34
    v_cvt_pk_bf16_f32 v40, v80, v81
    v_cvt_pk_bf16_f32 v41, v82, v83
    v_cvt_pk_bf16_f32 v42, v84, v85
    v_cvt_pk_bf16_f32 v43, v86, v87
    v_cvt_pk_bf16_f32 v44, v88, v89
    v_cvt_pk_bf16_f32 v45, v90, v91
    v_cvt_pk_bf16_f32 v46, v92, v93
    v_cvt_pk_bf16_f32 v47, v94, v95
    s_nop 1
    s_waitcnt lgkmcnt(14)
    v_mfma_f32_32x32x16_bf16 v[160:175], v[128:131], v[40:43], v[160:175]
    s_waitcnt lgkmcnt(12)
    v_mfma_f32_32x32x16_bf16 v[176:191], v[132:135], v[40:43], v[176:191]
    s_waitcnt lgkmcnt(10)
    v_mfma_f32_32x32x16_bf16 v[192:207], v[136:139], v[40:43], v[192:207]
    s_waitcnt lgkmcnt(8)
    v_mfma_f32_32x32x16_bf16 v[208:223], v[140:143], v[40:43], v[208:223]
    s_waitcnt lgkmcnt(6)
    v_mfma_f32_32x32x16_bf16 v[160:175], v[144:147], v[44:47], v[160:175]
    s_waitcnt lgkmcnt(4)
    v_mfma_f32_32x32x16_bf16 v[176:191], v[148:151], v[44:47], v[176:191]
    s_waitcnt lgkmcnt(2)
    v_mfma_f32_32x32x16_bf16 v[192:207], v[152:155], v[44:47], v[192:207]
    s_waitcnt lgkmcnt(0)
    v_mfma_f32_32x32x16_bf16 v[208:223], v[156:159], v[44:47], v[208:223]
    s_waitcnt vmcnt(8)
    s_barrier
    s_add_u32 s25, s30, 0
    s_mov_b32 m0, s25
    s_add_u32 s26, s24, 0
    buffer_load_dwordx4 v2, s[4:7], s26 offen nt lds
    s_add_u32 s25, s30, 1024
    s_mov_b32 m0, s25
    s_add_u32 s26, s24, 1024
    buffer_load_dwordx4 v3, s[4:7], s26 offen nt lds
    s_add_u32 s25, s30, 16384
    s_mov_b32 m0, s25
    s_add_u32 s26, s24, 0
    buffer_load_dwordx4 v4, s[8:11], s26 offen nt lds
    s_add_u32 s25, s30, 17408
    s_mov_b32 m0, s25
    s_add_u32 s26, s24, 1024
    buffer_load_dwordx4 v4, s[8:11], s26 offen nt lds
    s_add_u32 s24, s24, 16384
    ds_read_b128 v[96:99], v5 offset:32768
    ds_read_b128 v[100:103], v6 offset:32768
    ds_read_b128 v[104:107], v7 offset:32768
    ds_read_b128 v[108:111], v8 offset:32768
    ds_read_b128 v[112:115], v9 offset:32768
    ds_read_b128 v[116:119], v10 offset:32768
    ds_read_b128 v[120:123], v11 offset:32768
    ds_read_b128 v[124:127], v12 offset:32768
    s_waitcnt lgkmcnt(7)
    v_mfma_f32_32x32x16_bf16 v[80:95], v[96:99], v[48:51], 0
    s_waitcnt lgkmcnt(6)
    v_mfma_f32_32x32x16_bf16 v[80:95], v[100:103], v[52:55], v[80:95]
    s_waitcnt lgkmcnt(5)
    v_mfma_f32_32x32x16_bf16 v[80:95], v[104:107], v[56:59], v[80:95]
    s_waitcnt lgkmcnt(4)
    v_mfma_f32_32x32x16_bf16 v[80:95], v[108:111], v[60:63], v[80:95]
    s_waitcnt lgkmcnt(3)
    v_mfma_f32_32x32x16_bf16 v[80:95], v[112:115], v[64:67], v[80:95]
    s_waitcnt lgkmcnt(2)
    v_mfma_f32_32x32x16_bf16 v[80:95], v[116:119], v[68:71], v[80:95]
    s_waitcnt lgkmcnt(1)
    v_mfma_f32_32x32x16_bf16 v[80:95], v[120:123], v[72:75], v[80:95]
    s_waitcnt lgkmcnt(0)
    v_mfma_f32_32x32x16_bf16 v[80:95], v[124:127], v[76:79], v[80:95]
    ds_read_b64_tr_b16 v[128:129], v13 offset:32768
    ds_read_b64_tr_b16 v[130:131], v13 offset:34816
    ds_read_b64_tr_b16 v[132:133], v14 offset:32768
    ds_read_b64_tr_b16 v[134:135], v14 offset:34816
    ds_read_b64_tr_b16 v[136:137], v15 offset:32768
    ds_read_b64_tr_b16 v[138:139], v15 offset:34816
    ds_read_b64_tr_b16 v[140:141], v16 offset:32768
    ds_read_b64_tr_b16 v[142:143], v16 offset:34816
    ds_read_b64_tr_b16 v[144:145], v13 offset:36864
    ds_read_b64_tr_b16 v[146:147], v13 offset:38912
    ds_read_b64_tr_b16 v[148:149], v14 offset:36864
    ds_read_b64_tr_b16 v[150:151], v14 offset:38912
    ds_read_b64_tr_b16 v[152:153], v15 offset:36864
    ds_read_b64_tr_b16 v[154:155], v15 offset:38912
    ds_read_b64_tr_b16 v[156:157], v16 offset:36864
    ds_read_b64_tr_b16 v[158:159], v16 offset:38912
    s_nop 7
    s_nop 3
    v_max3_f32 v32, v80, v81, v82
    v_max3_f32 v33, v83, v84, v85
    v_max3_f32 v34, v86, v87, v88
    v_max3_f32 v35, v89, v90, v91
    v_max3_f32 v36, v92, v93, v94
    v_max3_f32 v32, v32, v33, v34
    v_max3_f32 v35, v35, v36, v95
    v_max_f32 v32, v32, v35
    v_mov_b32 v33, v32
    s_nop 1
    v_permlane32_swap_b32 v32, v33
    v_max_f32 v32, v32, v33
    v_mul_f32 v32, s28, v32
    v_max_f32 v33, v29, v32
    v_sub_f32 v34, v33, v29
    v_cmp_gt_f32 vcc, v34, s32
    s_cmp_lg_u64 vcc, 0
    s_cbranch_scc0 attn_kernel_skip4
    v_sub_f32 v34, v29, v33
    v_exp_f32 v31, v34
    v_mov_b32 v29, v33
    v_mul_f32 v30, v30, v31
    v_mul_f32 v160, v160, v31
    v_mul_f32 v161, v161, v31
    v_mul_f32 v162, v162, v31
    v_mul_f32 v163, v163, v31
    v_mul_f32 v164, v164, v31
    v_mul_f32 v165, v165, v31
    v_mul_f32 v166, v166, v31
    v_mul_f32 v167, v167, v31
    v_mul_f32 v168, v168, v31
    v_mul_f32 v169, v169, v31
    v_mul_f32 v170, v170, v31
    v_mul_f32 v171, v171, v31
    v_mul_f32 v172, v172, v31
    v_mul_f32 v173, v173, v31
    v_mul_f32 v174, v174, v31
    v_mul_f32 v175, v175, v31
    v_mul_f32 v176, v176, v31
    v_mul_f32 v177, v177, v31
    v_mul_f32 v178, v178, v31
    v_mul_f32 v179, v179, v31
    v_mul_f32 v180, v180, v31
    v_mul_f32 v181, v181, v31
    v_mul_f32 v182, v182, v31
    v_mul_f32 v183, v183, v31
    v_mul_f32 v184, v184, v31
    v_mul_f32 v185, v185, v31
    v_mul_f32 v186, v186, v31
    v_mul_f32 v187, v187, v31
    v_mul_f32 v188, v188, v31
    v_mul_f32 v189, v189, v31
    v_mul_f32 v190, v190, v31
    v_mul_f32 v191, v191, v31
    v_mul_f32 v192, v192, v31
    v_mul_f32 v193, v193, v31
    v_mul_f32 v194, v194, v31
    v_mul_f32 v195, v195, v31
    v_mul_f32 v196, v196, v31
    v_mul_f32 v197, v197, v31
    v_mul_f32 v198, v198, v31
    v_mul_f32 v199, v199, v31
    v_mul_f32 v200, v200, v31
    v_mul_f32 v201, v201, v31
    v_mul_f32 v202, v202, v31
    v_mul_f32 v203, v203, v31
    v_mul_f32 v204, v204, v31
    v_mul_f32 v205, v205, v31
    v_mul_f32 v206, v206, v31
    v_mul_f32 v207, v207, v31
    v_mul_f32 v208, v208, v31
    v_mul_f32 v209, v209, v31
    v_mul_f32 v210, v210, v31
    v_mul_f32 v211, v211, v31
    v_mul_f32 v212, v212, v31
    v_mul_f32 v213, v213, v31
    v_mul_f32 v214, v214, v31
    v_mul_f32 v215, v215, v31
    v_mul_f32 v216, v216, v31
    v_mul_f32 v217, v217, v31
    v_mul_f32 v218, v218, v31
    v_mul_f32 v219, v219, v31
    v_mul_f32 v220, v220, v31
    v_mul_f32 v221, v221, v31
    v_mul_f32 v222, v222, v31
    v_mul_f32 v223, v223, v31
attn_kernel_skip4:
    v_fma_f32 v80, v80, s28, -v29
    v_fma_f32 v81, v81, s28, -v29
    v_fma_f32 v82, v82, s28, -v29
    v_fma_f32 v83, v83, s28, -v29
    v_fma_f32 v84, v84, s28, -v29
    v_fma_f32 v85, v85, s28, -v29
    v_fma_f32 v86, v86, s28, -v29
    v_fma_f32 v87, v87, s28, -v29
    v_fma_f32 v88, v88, s28, -v29
    v_fma_f32 v89, v89, s28, -v29
    v_fma_f32 v90, v90, s28, -v29
    v_fma_f32 v91, v91, s28, -v29
    v_fma_f32 v92, v92, s28, -v29
    v_fma_f32 v93, v93, s28, -v29
    v_fma_f32 v94, v94, s28, -v29
    v_fma_f32 v95, v95, s28, -v29
    v_exp_f32 v80, v80
    v_exp_f32 v81, v81
    v_exp_f32 v82, v82
    v_exp_f32 v83, v83
    v_exp_f32 v84, v84
    v_exp_f32 v85, v85
    v_exp_f32 v86, v86
    v_exp_f32 v87, v87
    v_exp_f32 v88, v88
    v_exp_f32 v89, v89
    v_exp_f32 v90, v90
    v_exp_f32 v91, v91
    v_exp_f32 v92, v92
    v_exp_f32 v93, v93
    v_exp_f32 v94, v94
    v_exp_f32 v95, v95
    v_add_f32 v34, v80, v81
    v_add_f32 v30, v30, v34
    v_add_f32 v34, v82, v83
    v_add_f32 v30, v30, v34
    v_add_f32 v34, v84, v85
    v_add_f32 v30, v30, v34
    v_add_f32 v34, v86, v87
    v_add_f32 v30, v30, v34
    v_add_f32 v34, v88, v89
    v_add_f32 v30, v30, v34
    v_add_f32 v34, v90, v91
    v_add_f32 v30, v30, v34
    v_add_f32 v34, v92, v93
    v_add_f32 v30, v30, v34
    v_add_f32 v34, v94, v95
    v_add_f32 v30, v30, v34
    v_cvt_pk_bf16_f32 v40, v80, v81
    v_cvt_pk_bf16_f32 v41, v82, v83
    v_cvt_pk_bf16_f32 v42, v84, v85
    v_cvt_pk_bf16_f32 v43, v86, v87
    v_cvt_pk_bf16_f32 v44, v88, v89
    v_cvt_pk_bf16_f32 v45, v90, v91
    v_cvt_pk_bf16_f32 v46, v92, v93
    v_cvt_pk_bf16_f32 v47, v94, v95
    s_nop 1
    s_waitcnt lgkmcnt(14)
    v_mfma_f32_32x32x16_bf16 v[160:175], v[128:131], v[40:43], v[160:175]
    s_waitcnt lgkmcnt(12)
    v_mfma_f32_32x32x16_bf16 v[176:191], v[132:135], v[40:43], v[176:191]
    s_waitcnt lgkmcnt(10)
    v_mfma_f32_32x32x16_bf16 v[192:207], v[136:139], v[40:43], v[192:207]
    s_waitcnt lgkmcnt(8)
    v_mfma_f32_32x32x16_bf16 v[208:223], v[140:143], v[40:43], v[208:223]
    s_waitcnt lgkmcnt(6)
    v_mfma_f32_32x32x16_bf16 v[160:175], v[144:147], v[44:47], v[160:175]
    s_waitcnt lgkmcnt(4)
    v_mfma_f32_32x32x16_bf16 v[176:191], v[148:151], v[44:47], v[176:191]
    s_waitcnt lgkmcnt(2)
    v_mfma_f32_32x32x16_bf16 v[192:207], v[152:155], v[44:47], v[192:207]
    s_waitcnt lgkmcnt(0)
    v_mfma_f32_32x32x16_bf16 v[208:223], v[156:159], v[44:47], v[208:223]
    s_waitcnt vmcnt(8)
    s_barrier
    s_add_u32 s25, s30, 32768
    s_mov_b32 m0, s25
    s_add_u32 s26, s24, 0
    buffer_load_dwordx4 v2, s[4:7], s26 offen nt lds
    s_add_u32 s25, s30, 33792
    s_mov_b32 m0, s25
    s_add_u32 s26, s24, 1024
    buffer_load_dwordx4 v3, s[4:7], s26 offen nt lds
    s_add_u32 s25, s30, 49152
    s_mov_b32 m0, s25
    s_add_u32 s26, s24, 0
    buffer_load_dwordx4 v4, s[8:11], s26 offen nt lds
    s_add_u32 s25, s30, 50176
    s_mov_b32 m0, s25
    s_add_u32 s26, s24, 1024
    buffer_load_dwordx4 v4, s[8:11], s26 offen nt lds
    s_add_u32 s24, s24, 16384
    ds_read_b128 v[96:99], v17 offset:0
    ds_read_b128 v[100:103], v18 offset:0
    ds_read_b128 v[104:107], v19 offset:0
    ds_read_b128 v[108:111], v20 offset:0
    ds_read_b128 v[112:115], v21 offset:0
    ds_read_b128 v[116:119], v22 offset:0
    ds_read_b128 v[120:123], v23 offset:0
    ds_read_b128 v[124:127], v24 offset:0
    s_waitcnt lgkmcnt(7)
    v_mfma_f32_32x32x16_bf16 v[80:95], v[96:99], v[48:51], 0
    s_waitcnt lgkmcnt(6)
    v_mfma_f32_32x32x16_bf16 v[80:95], v[100:103], v[52:55], v[80:95]
    s_waitcnt lgkmcnt(5)
    v_mfma_f32_32x32x16_bf16 v[80:95], v[104:107], v[56:59], v[80:95]
    s_waitcnt lgkmcnt(4)
    v_mfma_f32_32x32x16_bf16 v[80:95], v[108:111], v[60:63], v[80:95]
    s_waitcnt lgkmcnt(3)
    v_mfma_f32_32x32x16_bf16 v[80:95], v[112:115], v[64:67], v[80:95]
    s_waitcnt lgkmcnt(2)
    v_mfma_f32_32x32x16_bf16 v[80:95], v[116:119], v[68:71], v[80:95]
    s_waitcnt lgkmcnt(1)
    v_mfma_f32_32x32x16_bf16 v[80:95], v[120:123], v[72:75], v[80:95]
    s_waitcnt lgkmcnt(0)
    v_mfma_f32_32x32x16_bf16 v[80:95], v[124:127], v[76:79], v[80:95]
    ds_read_b64_tr_b16 v[128:129], v25 offset:0
    ds_read_b64_tr_b16 v[130:131], v25 offset:2048
    ds_read_b64_tr_b16 v[132:133], v26 offset:0
    ds_read_b64_tr_b16 v[134:135], v26 offset:2048
    ds_read_b64_tr_b16 v[136:137], v27 offset:0
    ds_read_b64_tr_b16 v[138:139], v27 offset:2048
    ds_read_b64_tr_b16 v[140:141], v28 offset:0
    ds_read_b64_tr_b16 v[142:143], v28 offset:2048
    ds_read_b64_tr_b16 v[144:145], v25 offset:4096
    ds_read_b64_tr_b16 v[146:147], v25 offset:6144
    ds_read_b64_tr_b16 v[148:149], v26 offset:4096
    ds_read_b64_tr_b16 v[150:151], v26 offset:6144
    ds_read_b64_tr_b16 v[152:153], v27 offset:4096
    ds_read_b64_tr_b16 v[154:155], v27 offset:6144
    ds_read_b64_tr_b16 v[156:157], v28 offset:4096
    ds_read_b64_tr_b16 v[158:159], v28 offset:6144
    s_nop 7
    s_nop 3
    v_max3_f32 v32, v80, v81, v82
    v_max3_f32 v33, v83, v84, v85
    v_max3_f32 v34, v86, v87, v88
    v_max3_f32 v35, v89, v90, v91
    v_max3_f32 v36, v92, v93, v94
    v_max3_f32 v32, v32, v33, v34
    v_max3_f32 v35, v35, v36, v95
    v_max_f32 v32, v32, v35
    v_mov_b32 v33, v32
    s_nop 1
    v_permlane32_swap_b32 v32, v33
    v_max_f32 v32, v32, v33
    v_mul_f32 v32, s28, v32
    v_max_f32 v33, v29, v32
    v_sub_f32 v34, v33, v29
    v_cmp_gt_f32 vcc, v34, s32
    s_cmp_lg_u64 vcc, 0
    s_cbranch_scc0 attn_kernel_skip5
    v_sub_f32 v34, v29, v33
    v_exp_f32 v31, v34
    v_mov_b32 v29, v33
    v_mul_f32 v30, v30, v31
    v_mul_f32 v160, v160, v31
    v_mul_f32 v161, v161, v31
    v_mul_f32 v162, v162, v31
    v_mul_f32 v163, v163, v31
    v_mul_f32 v164, v164, v31
    v_mul_f32 v165, v165, v31
    v_mul_f32 v166, v166, v31
    v_mul_f32 v167, v167, v31
    v_mul_f32 v168, v168, v31
    v_mul_f32 v169, v169, v31
    v_mul_f32 v170, v170, v31
    v_mul_f32 v171, v171, v31
    v_mul_f32 v172, v172, v31
    v_mul_f32 v173, v173, v31
    v_mul_f32 v174, v174, v31
    v_mul_f32 v175, v175, v31
    v_mul_f32 v176, v176, v31
    v_mul_f32 v177, v177, v31
    v_mul_f32 v178, v178, v31
    v_mul_f32 v179, v179, v31
    v_mul_f32 v180, v180, v31
    v_mul_f32 v181, v181, v31
    v_mul_f32 v182, v182, v31
    v_mul_f32 v183, v183, v31
    v_mul_f32 v184, v184, v31
    v_mul_f32 v185, v185, v31
    v_mul_f32 v186, v186, v31
    v_mul_f32 v187, v187, v31
    v_mul_f32 v188, v188, v31
    v_mul_f32 v189, v189, v31
    v_mul_f32 v190, v190, v31
    v_mul_f32 v191, v191, v31
    v_mul_f32 v192, v192, v31
    v_mul_f32 v193, v193, v31
    v_mul_f32 v194, v194, v31
    v_mul_f32 v195, v195, v31
    v_mul_f32 v196, v196, v31
    v_mul_f32 v197, v197, v31
    v_mul_f32 v198, v198, v31
    v_mul_f32 v199, v199, v31
    v_mul_f32 v200, v200, v31
    v_mul_f32 v201, v201, v31
    v_mul_f32 v202, v202, v31
    v_mul_f32 v203, v203, v31
    v_mul_f32 v204, v204, v31
    v_mul_f32 v205, v205, v31
    v_mul_f32 v206, v206, v31
    v_mul_f32 v207, v207, v31
    v_mul_f32 v208, v208, v31
    v_mul_f32 v209, v209, v31
    v_mul_f32 v210, v210, v31
    v_mul_f32 v211, v211, v31
    v_mul_f32 v212, v212, v31
    v_mul_f32 v213, v213, v31
    v_mul_f32 v214, v214, v31
    v_mul_f32 v215, v215, v31
    v_mul_f32 v216, v216, v31
    v_mul_f32 v217, v217, v31
    v_mul_f32 v218, v218, v31
    v_mul_f32 v219, v219, v31
    v_mul_f32 v220, v220, v31
    v_mul_f32 v221, v221, v31
    v_mul_f32 v222, v222, v31
    v_mul_f32 v223, v223, v31
attn_kernel_skip5:
    v_fma_f32 v80, v80, s28, -v29
    v_fma_f32 v81, v81, s28, -v29
    v_fma_f32 v82, v82, s28, -v29
    v_fma_f32 v83, v83, s28, -v29
    v_fma_f32 v84, v84, s28, -v29
    v_fma_f32 v85, v85, s28, -v29
    v_fma_f32 v86, v86, s28, -v29
    v_fma_f32 v87, v87, s28, -v29
    v_fma_f32 v88, v88, s28, -v29
    v_fma_f32 v89, v89, s28, -v29
    v_fma_f32 v90, v90, s28, -v29
    v_fma_f32 v91, v91, s28, -v29
    v_fma_f32 v92, v92, s28, -v29
    v_fma_f32 v93, v93, s28, -v29
    v_fma_f32 v94, v94, s28, -v29
    v_fma_f32 v95, v95, s28, -v29
    v_exp_f32 v80, v80
    v_exp_f32 v81, v81
    v_exp_f32 v82, v82
    v_exp_f32 v83, v83
    v_exp_f32 v84, v84
    v_exp_f32 v85, v85
    v_exp_f32 v86, v86
    v_exp_f32 v87, v87
    v_exp_f32 v88, v88
    v_exp_f32 v89, v89
    v_exp_f32 v90, v90
    v_exp_f32 v91, v91
    v_exp_f32 v92, v92
    v_exp_f32 v93, v93
    v_exp_f32 v94, v94
    v_exp_f32 v95, v95
    v_add_f32 v34, v80, v81
    v_add_f32 v30, v30, v34
    v_add_f32 v34, v82, v83
    v_add_f32 v30, v30, v34
    v_add_f32 v34, v84, v85
    v_add_f32 v30, v30, v34
    v_add_f32 v34, v86, v87
    v_add_f32 v30, v30, v34
    v_add_f32 v34, v88, v89
    v_add_f32 v30, v30, v34
    v_add_f32 v34, v90, v91
    v_add_f32 v30, v30, v34
    v_add_f32 v34, v92, v93
    v_add_f32 v30, v30, v34
    v_add_f32 v34, v94, v95
    v_add_f32 v30, v30, v34
    v_cvt_pk_bf16_f32 v40, v80, v81
    v_cvt_pk_bf16_f32 v41, v82, v83
    v_cvt_pk_bf16_f32 v42, v84, v85
    v_cvt_pk_bf16_f32 v43, v86, v87
    v_cvt_pk_bf16_f32 v44, v88, v89
    v_cvt_pk_bf16_f32 v45, v90, v91
    v_cvt_pk_bf16_f32 v46, v92, v93
    v_cvt_pk_bf16_f32 v47, v94, v95
    s_nop 1
    s_waitcnt lgkmcnt(14)
    v_mfma_f32_32x32x16_bf16 v[160:175], v[128:131], v[40:43], v[160:175]
    s_waitcnt lgkmcnt(12)
    v_mfma_f32_32x32x16_bf16 v[176:191], v[132:135], v[40:43], v[176:191]
    s_waitcnt lgkmcnt(10)
    v_mfma_f32_32x32x16_bf16 v[192:207], v[136:139], v[40:43], v[192:207]
    s_waitcnt lgkmcnt(8)
    v_mfma_f32_32x32x16_bf16 v[208:223], v[140:143], v[40:43], v[208:223]
    s_waitcnt lgkmcnt(6)
    v_mfma_f32_32x32x16_bf16 v[160:175], v[144:147], v[44:47], v[160:175]
    s_waitcnt lgkmcnt(4)
    v_mfma_f32_32x32x16_bf16 v[176:191], v[148:151], v[44:47], v[176:191]
    s_waitcnt lgkmcnt(2)
    v_mfma_f32_32x32x16_bf16 v[192:207], v[152:155], v[44:47], v[192:207]
    s_waitcnt lgkmcnt(0)
    v_mfma_f32_32x32x16_bf16 v[208:223], v[156:159], v[44:47], v[208:223]
    s_waitcnt vmcnt(8)
    s_barrier
    s_add_u32 s25, s30, 65536
    s_mov_b32 m0, s25
    s_add_u32 s26, s24, 0
    buffer_load_dwordx4 v2, s[4:7], s26 offen nt lds
    s_add_u32 s25, s30, 66560
    s_mov_b32 m0, s25
    s_add_u32 s26, s24, 1024
    buffer_load_dwordx4 v3, s[4:7], s26 offen nt lds
    s_add_u32 s25, s30, 81920
    s_mov_b32 m0, s25
    s_add_u32 s26, s24, 0
    buffer_load_dwordx4 v4, s[8:11], s26 offen nt lds
    s_add_u32 s25, s30, 82944
    s_mov_b32 m0, s25
    s_add_u32 s26, s24, 1024
    buffer_load_dwordx4 v4, s[8:11], s26 offen nt lds
    s_add_u32 s24, s24, 16384
    ds_read_b128 v[96:99], v17 offset:32768
    ds_read_b128 v[100:103], v18 offset:32768
    ds_read_b128 v[104:107], v19 offset:32768
    ds_read_b128 v[108:111], v20 offset:32768
    ds_read_b128 v[112:115], v21 offset:32768
    ds_read_b128 v[116:119], v22 offset:32768
    ds_read_b128 v[120:123], v23 offset:32768
    ds_read_b128 v[124:127], v24 offset:32768
    s_waitcnt lgkmcnt(7)
    v_mfma_f32_32x32x16_bf16 v[80:95], v[96:99], v[48:51], 0
    s_waitcnt lgkmcnt(6)
    v_mfma_f32_32x32x16_bf16 v[80:95], v[100:103], v[52:55], v[80:95]
    s_waitcnt lgkmcnt(5)
    v_mfma_f32_32x32x16_bf16 v[80:95], v[104:107], v[56:59], v[80:95]
    s_waitcnt lgkmcnt(4)
    v_mfma_f32_32x32x16_bf16 v[80:95], v[108:111], v[60:63], v[80:95]
    s_waitcnt lgkmcnt(3)
    v_mfma_f32_32x32x16_bf16 v[80:95], v[112:115], v[64:67], v[80:95]
    s_waitcnt lgkmcnt(2)
    v_mfma_f32_32x32x16_bf16 v[80:95], v[116:119], v[68:71], v[80:95]
    s_waitcnt lgkmcnt(1)
    v_mfma_f32_32x32x16_bf16 v[80:95], v[120:123], v[72:75], v[80:95]
    s_waitcnt lgkmcnt(0)
    v_mfma_f32_32x32x16_bf16 v[80:95], v[124:127], v[76:79], v[80:95]
    ds_read_b64_tr_b16 v[128:129], v25 offset:32768
    ds_read_b64_tr_b16 v[130:131], v25 offset:34816
    ds_read_b64_tr_b16 v[132:133], v26 offset:32768
    ds_read_b64_tr_b16 v[134:135], v26 offset:34816
    ds_read_b64_tr_b16 v[136:137], v27 offset:32768
    ds_read_b64_tr_b16 v[138:139], v27 offset:34816
    ds_read_b64_tr_b16 v[140:141], v28 offset:32768
    ds_read_b64_tr_b16 v[142:143], v28 offset:34816
    ds_read_b64_tr_b16 v[144:145], v25 offset:36864
    ds_read_b64_tr_b16 v[146:147], v25 offset:38912
    ds_read_b64_tr_b16 v[148:149], v26 offset:36864
    ds_read_b64_tr_b16 v[150:151], v26 offset:38912
    ds_read_b64_tr_b16 v[152:153], v27 offset:36864
    ds_read_b64_tr_b16 v[154:155], v27 offset:38912
    ds_read_b64_tr_b16 v[156:157], v28 offset:36864
    ds_read_b64_tr_b16 v[158:159], v28 offset:38912
    s_nop 7
    s_nop 3
    v_max3_f32 v32, v80, v81, v82
    v_max3_f32 v33, v83, v84, v85
    v_max3_f32 v34, v86, v87, v88
    v_max3_f32 v35, v89, v90, v91
    v_max3_f32 v36, v92, v93, v94
    v_max3_f32 v32, v32, v33, v34
    v_max3_f32 v35, v35, v36, v95
    v_max_f32 v32, v32, v35
    v_mov_b32 v33, v32
    s_nop 1
    v_permlane32_swap_b32 v32, v33
    v_max_f32 v32, v32, v33
    v_mul_f32 v32, s28, v32
    v_max_f32 v33, v29, v32
    v_sub_f32 v34, v33, v29
    v_cmp_gt_f32 vcc, v34, s32
    s_cmp_lg_u64 vcc, 0
    s_cbranch_scc0 attn_kernel_skip6
    v_sub_f32 v34, v29, v33
    v_exp_f32 v31, v34
    v_mov_b32 v29, v33
    v_mul_f32 v30, v30, v31
    v_mul_f32 v160, v160, v31
    v_mul_f32 v161, v161, v31
    v_mul_f32 v162, v162, v31
    v_mul_f32 v163, v163, v31
    v_mul_f32 v164, v164, v31
    v_mul_f32 v165, v165, v31
    v_mul_f32 v166, v166, v31
    v_mul_f32 v167, v167, v31
    v_mul_f32 v168, v168, v31
    v_mul_f32 v169, v169, v31
    v_mul_f32 v170, v170, v31
    v_mul_f32 v171, v171, v31
    v_mul_f32 v172, v172, v31
    v_mul_f32 v173, v173, v31
    v_mul_f32 v174, v174, v31
    v_mul_f32 v175, v175, v31
    v_mul_f32 v176, v176, v31
    v_mul_f32 v177, v177, v31
    v_mul_f32 v178, v178, v31
    v_mul_f32 v179, v179, v31
    v_mul_f32 v180, v180, v31
    v_mul_f32 v181, v181, v31
    v_mul_f32 v182, v182, v31
    v_mul_f32 v183, v183, v31
    v_mul_f32 v184, v184, v31
    v_mul_f32 v185, v185, v31
    v_mul_f32 v186, v186, v31
    v_mul_f32 v187, v187, v31
    v_mul_f32 v188, v188, v31
    v_mul_f32 v189, v189, v31
    v_mul_f32 v190, v190, v31
    v_mul_f32 v191, v191, v31
    v_mul_f32 v192, v192, v31
    v_mul_f32 v193, v193, v31
    v_mul_f32 v194, v194, v31
    v_mul_f32 v195, v195, v31
    v_mul_f32 v196, v196, v31
    v_mul_f32 v197, v197, v31
    v_mul_f32 v198, v198, v31
    v_mul_f32 v199, v199, v31
    v_mul_f32 v200, v200, v31
    v_mul_f32 v201, v201, v31
    v_mul_f32 v202, v202, v31
    v_mul_f32 v203, v203, v31
    v_mul_f32 v204, v204, v31
    v_mul_f32 v205, v205, v31
    v_mul_f32 v206, v206, v31
    v_mul_f32 v207, v207, v31
    v_mul_f32 v208, v208, v31
    v_mul_f32 v209, v209, v31
    v_mul_f32 v210, v210, v31
    v_mul_f32 v211, v211, v31
    v_mul_f32 v212, v212, v31
    v_mul_f32 v213, v213, v31
    v_mul_f32 v214, v214, v31
    v_mul_f32 v215, v215, v31
    v_mul_f32 v216, v216, v31
    v_mul_f32 v217, v217, v31
    v_mul_f32 v218, v218, v31
    v_mul_f32 v219, v219, v31
    v_mul_f32 v220, v220, v31
    v_mul_f32 v221, v221, v31
    v_mul_f32 v222, v222, v31
    v_mul_f32 v223, v223, v31
attn_kernel_skip6:
    v_fma_f32 v80, v80, s28, -v29
    v_fma_f32 v81, v81, s28, -v29
    v_fma_f32 v82, v82, s28, -v29
    v_fma_f32 v83, v83, s28, -v29
    v_fma_f32 v84, v84, s28, -v29
    v_fma_f32 v85, v85, s28, -v29
    v_fma_f32 v86, v86, s28, -v29
    v_fma_f32 v87, v87, s28, -v29
    v_fma_f32 v88, v88, s28, -v29
    v_fma_f32 v89, v89, s28, -v29
    v_fma_f32 v90, v90, s28, -v29
    v_fma_f32 v91, v91, s28, -v29
    v_fma_f32 v92, v92, s28, -v29
    v_fma_f32 v93, v93, s28, -v29
    v_fma_f32 v94, v94, s28, -v29
    v_fma_f32 v95, v95, s28, -v29
    v_exp_f32 v80, v80
    v_exp_f32 v81, v81
    v_exp_f32 v82, v82
    v_exp_f32 v83, v83
    v_exp_f32 v84, v84
    v_exp_f32 v85, v85
    v_exp_f32 v86, v86
    v_exp_f32 v87, v87
    v_exp_f32 v88, v88
    v_exp_f32 v89, v89
    v_exp_f32 v90, v90
    v_exp_f32 v91, v91
    v_exp_f32 v92, v92
    v_exp_f32 v93, v93
    v_exp_f32 v94, v94
    v_exp_f32 v95, v95
    v_add_f32 v34, v80, v81
    v_add_f32 v30, v30, v34
    v_add_f32 v34, v82, v83
    v_add_f32 v30, v30, v34
    v_add_f32 v34, v84, v85
    v_add_f32 v30, v30, v34
    v_add_f32 v34, v86, v87
    v_add_f32 v30, v30, v34
    v_add_f32 v34, v88, v89
    v_add_f32 v30, v30, v34
    v_add_f32 v34, v90, v91
    v_add_f32 v30, v30, v34
    v_add_f32 v34, v92, v93
    v_add_f32 v30, v30, v34
    v_add_f32 v34, v94, v95
    v_add_f32 v30, v30, v34
    v_cvt_pk_bf16_f32 v40, v80, v81
    v_cvt_pk_bf16_f32 v41, v82, v83
    v_cvt_pk_bf16_f32 v42, v84, v85
    v_cvt_pk_bf16_f32 v43, v86, v87
    v_cvt_pk_bf16_f32 v44, v88, v89
    v_cvt_pk_bf16_f32 v45, v90, v91
    v_cvt_pk_bf16_f32 v46, v92, v93
    v_cvt_pk_bf16_f32 v47, v94, v95
    s_nop 1
    s_waitcnt lgkmcnt(14)
    v_mfma_f32_32x32x16_bf16 v[160:175], v[128:131], v[40:43], v[160:175]
    s_waitcnt lgkmcnt(12)
    v_mfma_f32_32x32x16_bf16 v[176:191], v[132:135], v[40:43], v[176:191]
    s_waitcnt lgkmcnt(10)
    v_mfma_f32_32x32x16_bf16 v[192:207], v[136:139], v[40:43], v[192:207]
    s_waitcnt lgkmcnt(8)
    v_mfma_f32_32x32x16_bf16 v[208:223], v[140:143], v[40:43], v[208:223]
    s_waitcnt lgkmcnt(6)
    v_mfma_f32_32x32x16_bf16 v[160:175], v[144:147], v[44:47], v[160:175]
    s_waitcnt lgkmcnt(4)
    v_mfma_f32_32x32x16_bf16 v[176:191], v[148:151], v[44:47], v[176:191]
    s_waitcnt lgkmcnt(2)
    v_mfma_f32_32x32x16_bf16 v[192:207], v[152:155], v[44:47], v[192:207]
    s_waitcnt lgkmcnt(0)
    v_mfma_f32_32x32x16_bf16 v[208:223], v[156:159], v[44:47], v[208:223]
    s_waitcnt vmcnt(8)
    s_barrier
    s_add_u32 s25, s30, 98304
    s_mov_b32 m0, s25
    s_add_u32 s26, s24, 0
    buffer_load_dwordx4 v2, s[4:7], s26 offen nt lds
    s_add_u32 s25, s30, 99328
    s_mov_b32 m0, s25
    s_add_u32 s26, s24, 1024
    buffer_load_dwordx4 v3, s[4:7], s26 offen nt lds
    s_add_u32 s25, s30, 114688
    s_mov_b32 m0, s25
    s_add_u32 s26, s24, 0
    buffer_load_dwordx4 v4, s[8:11], s26 offen nt lds
    s_add_u32 s25, s30, 115712
    s_mov_b32 m0, s25
    s_add_u32 s26, s24, 1024
    buffer_load_dwordx4 v4, s[8:11], s26 offen nt lds
    s_add_u32 s24, s24, 16384
    ds_read_b128 v[96:99], v5 offset:0
    ds_read_b128 v[100:103], v6 offset:0
    ds_read_b128 v[104:107], v7 offset:0
    ds_read_b128 v[108:111], v8 offset:0
    ds_read_b128 v[112:115], v9 offset:0
    ds_read_b128 v[116:119], v10 offset:0
    ds_read_b128 v[120:123], v11 offset:0
    ds_read_b128 v[124:127], v12 offset:0
    s_waitcnt lgkmcnt(7)
    v_mfma_f32_32x32x16_bf16 v[80:95], v[96:99], v[48:51], 0
    s_waitcnt lgkmcnt(6)
    v_mfma_f32_32x32x16_bf16 v[80:95], v[100:103], v[52:55], v[80:95]
    s_waitcnt lgkmcnt(5)
    v_mfma_f32_32x32x16_bf16 v[80:95], v[104:107], v[56:59], v[80:95]
    s_waitcnt lgkmcnt(4)
    v_mfma_f32_32x32x16_bf16 v[80:95], v[108:111], v[60:63], v[80:95]
    s_waitcnt lgkmcnt(3)
    v_mfma_f32_32x32x16_bf16 v[80:95], v[112:115], v[64:67], v[80:95]
    s_waitcnt lgkmcnt(2)
    v_mfma_f32_32x32x16_bf16 v[80:95], v[116:119], v[68:71], v[80:95]
    s_waitcnt lgkmcnt(1)
    v_mfma_f32_32x32x16_bf16 v[80:95], v[120:123], v[72:75], v[80:95]
    s_waitcnt lgkmcnt(0)
    v_mfma_f32_32x32x16_bf16 v[80:95], v[124:127], v[76:79], v[80:95]
    ds_read_b64_tr_b16 v[128:129], v13 offset:0
    ds_read_b64_tr_b16 v[130:131], v13 offset:2048
    ds_read_b64_tr_b16 v[132:133], v14 offset:0
    ds_read_b64_tr_b16 v[134:135], v14 offset:2048
    ds_read_b64_tr_b16 v[136:137], v15 offset:0
    ds_read_b64_tr_b16 v[138:139], v15 offset:2048
    ds_read_b64_tr_b16 v[140:141], v16 offset:0
    ds_read_b64_tr_b16 v[142:143], v16 offset:2048
    ds_read_b64_tr_b16 v[144:145], v13 offset:4096
    ds_read_b64_tr_b16 v[146:147], v13 offset:6144
    ds_read_b64_tr_b16 v[148:149], v14 offset:4096
    ds_read_b64_tr_b16 v[150:151], v14 offset:6144
    ds_read_b64_tr_b16 v[152:153], v15 offset:4096
    ds_read_b64_tr_b16 v[154:155], v15 offset:6144
    ds_read_b64_tr_b16 v[156:157], v16 offset:4096
    ds_read_b64_tr_b16 v[158:159], v16 offset:6144
    s_nop 7
    s_nop 3
    v_max3_f32 v32, v80, v81, v82
    v_max3_f32 v33, v83, v84, v85
    v_max3_f32 v34, v86, v87, v88
    v_max3_f32 v35, v89, v90, v91
    v_max3_f32 v36, v92, v93, v94
    v_max3_f32 v32, v32, v33, v34
    v_max3_f32 v35, v35, v36, v95
    v_max_f32 v32, v32, v35
    v_mov_b32 v33, v32
    s_nop 1
    v_permlane32_swap_b32 v32, v33
    v_max_f32 v32, v32, v33
    v_mul_f32 v32, s28, v32
    v_max_f32 v33, v29, v32
    v_sub_f32 v34, v33, v29
    v_cmp_gt_f32 vcc, v34, s32
    s_cmp_lg_u64 vcc, 0
    s_cbranch_scc0 attn_kernel_skip7
    v_sub_f32 v34, v29, v33
    v_exp_f32 v31, v34
    v_mov_b32 v29, v33
    v_mul_f32 v30, v30, v31
    v_mul_f32 v160, v160, v31
    v_mul_f32 v161, v161, v31
    v_mul_f32 v162, v162, v31
    v_mul_f32 v163, v163, v31
    v_mul_f32 v164, v164, v31
    v_mul_f32 v165, v165, v31
    v_mul_f32 v166, v166, v31
    v_mul_f32 v167, v167, v31
    v_mul_f32 v168, v168, v31
    v_mul_f32 v169, v169, v31
    v_mul_f32 v170, v170, v31
    v_mul_f32 v171, v171, v31
    v_mul_f32 v172, v172, v31
    v_mul_f32 v173, v173, v31
    v_mul_f32 v174, v174, v31
    v_mul_f32 v175, v175, v31
    v_mul_f32 v176, v176, v31
    v_mul_f32 v177, v177, v31
    v_mul_f32 v178, v178, v31
    v_mul_f32 v179, v179, v31
    v_mul_f32 v180, v180, v31
    v_mul_f32 v181, v181, v31
    v_mul_f32 v182, v182, v31
    v_mul_f32 v183, v183, v31
    v_mul_f32 v184, v184, v31
    v_mul_f32 v185, v185, v31
    v_mul_f32 v186, v186, v31
    v_mul_f32 v187, v187, v31
    v_mul_f32 v188, v188, v31
    v_mul_f32 v189, v189, v31
    v_mul_f32 v190, v190, v31
    v_mul_f32 v191, v191, v31
    v_mul_f32 v192, v192, v31
    v_mul_f32 v193, v193, v31
    v_mul_f32 v194, v194, v31
    v_mul_f32 v195, v195, v31
    v_mul_f32 v196, v196, v31
    v_mul_f32 v197, v197, v31
    v_mul_f32 v198, v198, v31
    v_mul_f32 v199, v199, v31
    v_mul_f32 v200, v200, v31
    v_mul_f32 v201, v201, v31
    v_mul_f32 v202, v202, v31
    v_mul_f32 v203, v203, v31
    v_mul_f32 v204, v204, v31
    v_mul_f32 v205, v205, v31
    v_mul_f32 v206, v206, v31
    v_mul_f32 v207, v207, v31
    v_mul_f32 v208, v208, v31
    v_mul_f32 v209, v209, v31
    v_mul_f32 v210, v210, v31
    v_mul_f32 v211, v211, v31
    v_mul_f32 v212, v212, v31
    v_mul_f32 v213, v213, v31
    v_mul_f32 v214, v214, v31
    v_mul_f32 v215, v215, v31
    v_mul_f32 v216, v216, v31
    v_mul_f32 v217, v217, v31
    v_mul_f32 v218, v218, v31
    v_mul_f32 v219, v219, v31
    v_mul_f32 v220, v220, v31
    v_mul_f32 v221, v221, v31
    v_mul_f32 v222, v222, v31
    v_mul_f32 v223, v223, v31
attn_kernel_skip7:
    v_fma_f32 v80, v80, s28, -v29
    v_fma_f32 v81, v81, s28, -v29
    v_fma_f32 v82, v82, s28, -v29
    v_fma_f32 v83, v83, s28, -v29
    v_fma_f32 v84, v84, s28, -v29
    v_fma_f32 v85, v85, s28, -v29
    v_fma_f32 v86, v86, s28, -v29
    v_fma_f32 v87, v87, s28, -v29
    v_fma_f32 v88, v88, s28, -v29
    v_fma_f32 v89, v89, s28, -v29
    v_fma_f32 v90, v90, s28, -v29
    v_fma_f32 v91, v91, s28, -v29
    v_fma_f32 v92, v92, s28, -v29
    v_fma_f32 v93, v93, s28, -v29
    v_fma_f32 v94, v94, s28, -v29
    v_fma_f32 v95, v95, s28, -v29
    v_exp_f32 v80, v80
    v_exp_f32 v81, v81
    v_exp_f32 v82, v82
    v_exp_f32 v83, v83
    v_exp_f32 v84, v84
    v_exp_f32 v85, v85
    v_exp_f32 v86, v86
    v_exp_f32 v87, v87
    v_exp_f32 v88, v88
    v_exp_f32 v89, v89
    v_exp_f32 v90, v90
    v_exp_f32 v91, v91
    v_exp_f32 v92, v92
    v_exp_f32 v93, v93
    v_exp_f32 v94, v94
    v_exp_f32 v95, v95
    v_add_f32 v34, v80, v81
    v_add_f32 v30, v30, v34
    v_add_f32 v34, v82, v83
    v_add_f32 v30, v30, v34
    v_add_f32 v34, v84, v85
    v_add_f32 v30, v30, v34
    v_add_f32 v34, v86, v87
    v_add_f32 v30, v30, v34
    v_add_f32 v34, v88, v89
    v_add_f32 v30, v30, v34
    v_add_f32 v34, v90, v91
    v_add_f32 v30, v30, v34
    v_add_f32 v34, v92, v93
    v_add_f32 v30, v30, v34
    v_add_f32 v34, v94, v95
    v_add_f32 v30, v30, v34
    v_cvt_pk_bf16_f32 v40, v80, v81
    v_cvt_pk_bf16_f32 v41, v82, v83
    v_cvt_pk_bf16_f32 v42, v84, v85
    v_cvt_pk_bf16_f32 v43, v86, v87
    v_cvt_pk_bf16_f32 v44, v88, v89
    v_cvt_pk_bf16_f32 v45, v90, v91
    v_cvt_pk_bf16_f32 v46, v92, v93
    v_cvt_pk_bf16_f32 v47, v94, v95
    s_nop 1
    s_waitcnt lgkmcnt(14)
    v_mfma_f32_32x32x16_bf16 v[160:175], v[128:131], v[40:43], v[160:175]
    s_waitcnt lgkmcnt(12)
    v_mfma_f32_32x32x16_bf16 v[176:191], v[132:135], v[40:43], v[176:191]
    s_waitcnt lgkmcnt(10)
    v_mfma_f32_32x32x16_bf16 v[192:207], v[136:139], v[40:43], v[192:207]
    s_waitcnt lgkmcnt(8)
    v_mfma_f32_32x32x16_bf16 v[208:223], v[140:143], v[40:43], v[208:223]
    s_waitcnt lgkmcnt(6)
    v_mfma_f32_32x32x16_bf16 v[160:175], v[144:147], v[44:47], v[160:175]
    s_waitcnt lgkmcnt(4)
    v_mfma_f32_32x32x16_bf16 v[176:191], v[148:151], v[44:47], v[176:191]
    s_waitcnt lgkmcnt(2)
    v_mfma_f32_32x32x16_bf16 v[192:207], v[152:155], v[44:47], v[192:207]
    s_waitcnt lgkmcnt(0)
    v_mfma_f32_32x32x16_bf16 v[208:223], v[156:159], v[44:47], v[208:223]
    s_waitcnt vmcnt(8)
    s_barrier
    s_add_u32 s25, s30, 0
    s_mov_b32 m0, s25
    s_add_u32 s26, s24, 0
    buffer_load_dwordx4 v2, s[4:7], s26 offen nt lds
    s_add_u32 s25, s30, 1024
    s_mov_b32 m0, s25
    s_add_u32 s26, s24, 1024
    buffer_load_dwordx4 v3, s[4:7], s26 offen nt lds
    s_add_u32 s25, s30, 16384
    s_mov_b32 m0, s25
    s_add_u32 s26, s24, 0
    buffer_load_dwordx4 v4, s[8:11], s26 offen nt lds
    s_add_u32 s25, s30, 17408
    s_mov_b32 m0, s25
    s_add_u32 s26, s24, 1024
    buffer_load_dwordx4 v4, s[8:11], s26 offen nt lds
    s_add_u32 s24, s24, 16384
    ds_read_b128 v[96:99], v5 offset:32768
    ds_read_b128 v[100:103], v6 offset:32768
    ds_read_b128 v[104:107], v7 offset:32768
    ds_read_b128 v[108:111], v8 offset:32768
    ds_read_b128 v[112:115], v9 offset:32768
    ds_read_b128 v[116:119], v10 offset:32768
    ds_read_b128 v[120:123], v11 offset:32768
    ds_read_b128 v[124:127], v12 offset:32768
    s_waitcnt lgkmcnt(7)
    v_mfma_f32_32x32x16_bf16 v[80:95], v[96:99], v[48:51], 0
    s_waitcnt lgkmcnt(6)
    v_mfma_f32_32x32x16_bf16 v[80:95], v[100:103], v[52:55], v[80:95]
    s_waitcnt lgkmcnt(5)
    v_mfma_f32_32x32x16_bf16 v[80:95], v[104:107], v[56:59], v[80:95]
    s_waitcnt lgkmcnt(4)
    v_mfma_f32_32x32x16_bf16 v[80:95], v[108:111], v[60:63], v[80:95]
    s_waitcnt lgkmcnt(3)
    v_mfma_f32_32x32x16_bf16 v[80:95], v[112:115], v[64:67], v[80:95]
    s_waitcnt lgkmcnt(2)
    v_mfma_f32_32x32x16_bf16 v[80:95], v[116:119], v[68:71], v[80:95]
    s_waitcnt lgkmcnt(1)
    v_mfma_f32_32x32x16_bf16 v[80:95], v[120:123], v[72:75], v[80:95]
    s_waitcnt lgkmcnt(0)
    v_mfma_f32_32x32x16_bf16 v[80:95], v[124:127], v[76:79], v[80:95]
    ds_read_b64_tr_b16 v[128:129], v13 offset:32768
    ds_read_b64_tr_b16 v[130:131], v13 offset:34816
    ds_read_b64_tr_b16 v[132:133], v14 offset:32768
    ds_read_b64_tr_b16 v[134:135], v14 offset:34816
    ds_read_b64_tr_b16 v[136:137], v15 offset:32768
    ds_read_b64_tr_b16 v[138:139], v15 offset:34816
    ds_read_b64_tr_b16 v[140:141], v16 offset:32768
    ds_read_b64_tr_b16 v[142:143], v16 offset:34816
    ds_read_b64_tr_b16 v[144:145], v13 offset:36864
    ds_read_b64_tr_b16 v[146:147], v13 offset:38912
    ds_read_b64_tr_b16 v[148:149], v14 offset:36864
    ds_read_b64_tr_b16 v[150:151], v14 offset:38912
    ds_read_b64_tr_b16 v[152:153], v15 offset:36864
    ds_read_b64_tr_b16 v[154:155], v15 offset:38912
    ds_read_b64_tr_b16 v[156:157], v16 offset:36864
    ds_read_b64_tr_b16 v[158:159], v16 offset:38912
    s_nop 7
    s_nop 3
    v_max3_f32 v32, v80, v81, v82
    v_max3_f32 v33, v83, v84, v85
    v_max3_f32 v34, v86, v87, v88
    v_max3_f32 v35, v89, v90, v91
    v_max3_f32 v36, v92, v93, v94
    v_max3_f32 v32, v32, v33, v34
    v_max3_f32 v35, v35, v36, v95
    v_max_f32 v32, v32, v35
    v_mov_b32 v33, v32
    s_nop 1
    v_permlane32_swap_b32 v32, v33
    v_max_f32 v32, v32, v33
    v_mul_f32 v32, s28, v32
    v_max_f32 v33, v29, v32
    v_sub_f32 v34, v33, v29
    v_cmp_gt_f32 vcc, v34, s32
    s_cmp_lg_u64 vcc, 0
    s_cbranch_scc0 attn_kernel_skip8
    v_sub_f32 v34, v29, v33
    v_exp_f32 v31, v34
    v_mov_b32 v29, v33
    v_mul_f32 v30, v30, v31
    v_mul_f32 v160, v160, v31
    v_mul_f32 v161, v161, v31
    v_mul_f32 v162, v162, v31
    v_mul_f32 v163, v163, v31
    v_mul_f32 v164, v164, v31
    v_mul_f32 v165, v165, v31
    v_mul_f32 v166, v166, v31
    v_mul_f32 v167, v167, v31
    v_mul_f32 v168, v168, v31
    v_mul_f32 v169, v169, v31
    v_mul_f32 v170, v170, v31
    v_mul_f32 v171, v171, v31
    v_mul_f32 v172, v172, v31
    v_mul_f32 v173, v173, v31
    v_mul_f32 v174, v174, v31
    v_mul_f32 v175, v175, v31
    v_mul_f32 v176, v176, v31
    v_mul_f32 v177, v177, v31
    v_mul_f32 v178, v178, v31
    v_mul_f32 v179, v179, v31
    v_mul_f32 v180, v180, v31
    v_mul_f32 v181, v181, v31
    v_mul_f32 v182, v182, v31
    v_mul_f32 v183, v183, v31
    v_mul_f32 v184, v184, v31
    v_mul_f32 v185, v185, v31
    v_mul_f32 v186, v186, v31
    v_mul_f32 v187, v187, v31
    v_mul_f32 v188, v188, v31
    v_mul_f32 v189, v189, v31
    v_mul_f32 v190, v190, v31
    v_mul_f32 v191, v191, v31
    v_mul_f32 v192, v192, v31
    v_mul_f32 v193, v193, v31
    v_mul_f32 v194, v194, v31
    v_mul_f32 v195, v195, v31
    v_mul_f32 v196, v196, v31
    v_mul_f32 v197, v197, v31
    v_mul_f32 v198, v198, v31
    v_mul_f32 v199, v199, v31
    v_mul_f32 v200, v200, v31
    v_mul_f32 v201, v201, v31
    v_mul_f32 v202, v202, v31
    v_mul_f32 v203, v203, v31
    v_mul_f32 v204, v204, v31
    v_mul_f32 v205, v205, v31
    v_mul_f32 v206, v206, v31
    v_mul_f32 v207, v207, v31
    v_mul_f32 v208, v208, v31
    v_mul_f32 v209, v209, v31
    v_mul_f32 v210, v210, v31
    v_mul_f32 v211, v211, v31
    v_mul_f32 v212, v212, v31
    v_mul_f32 v213, v213, v31
    v_mul_f32 v214, v214, v31
    v_mul_f32 v215, v215, v31
    v_mul_f32 v216, v216, v31
    v_mul_f32 v217, v217, v31
    v_mul_f32 v218, v218, v31
    v_mul_f32 v219, v219, v31
    v_mul_f32 v220, v220, v31
    v_mul_f32 v221, v221, v31
    v_mul_f32 v222, v222, v31
    v_mul_f32 v223, v223, v31
attn_kernel_skip8:
    v_fma_f32 v80, v80, s28, -v29
    v_fma_f32 v81, v81, s28, -v29
    v_fma_f32 v82, v82, s28, -v29
    v_fma_f32 v83, v83, s28, -v29
    v_fma_f32 v84, v84, s28, -v29
    v_fma_f32 v85, v85, s28, -v29
    v_fma_f32 v86, v86, s28, -v29
    v_fma_f32 v87, v87, s28, -v29
    v_fma_f32 v88, v88, s28, -v29
    v_fma_f32 v89, v89, s28, -v29
    v_fma_f32 v90, v90, s28, -v29
    v_fma_f32 v91, v91, s28, -v29
    v_fma_f32 v92, v92, s28, -v29
    v_fma_f32 v93, v93, s28, -v29
    v_fma_f32 v94, v94, s28, -v29
    v_fma_f32 v95, v95, s28, -v29
    v_exp_f32 v80, v80
    v_exp_f32 v81, v81
    v_exp_f32 v82, v82
    v_exp_f32 v83, v83
    v_exp_f32 v84, v84
    v_exp_f32 v85, v85
    v_exp_f32 v86, v86
    v_exp_f32 v87, v87
    v_exp_f32 v88, v88
    v_exp_f32 v89, v89
    v_exp_f32 v90, v90
    v_exp_f32 v91, v91
    v_exp_f32 v92, v92
    v_exp_f32 v93, v93
    v_exp_f32 v94, v94
    v_exp_f32 v95, v95
    v_add_f32 v34, v80, v81
    v_add_f32 v30, v30, v34
    v_add_f32 v34, v82, v83
    v_add_f32 v30, v30, v34
    v_add_f32 v34, v84, v85
    v_add_f32 v30, v30, v34
    v_add_f32 v34, v86, v87
    v_add_f32 v30, v30, v34
    v_add_f32 v34, v88, v89
    v_add_f32 v30, v30, v34
    v_add_f32 v34, v90, v91
    v_add_f32 v30, v30, v34
    v_add_f32 v34, v92, v93
    v_add_f32 v30, v30, v34
    v_add_f32 v34, v94, v95
    v_add_f32 v30, v30, v34
    v_cvt_pk_bf16_f32 v40, v80, v81
    v_cvt_pk_bf16_f32 v41, v82, v83
    v_cvt_pk_bf16_f32 v42, v84, v85
    v_cvt_pk_bf16_f32 v43, v86, v87
    v_cvt_pk_bf16_f32 v44, v88, v89
    v_cvt_pk_bf16_f32 v45, v90, v91
    v_cvt_pk_bf16_f32 v46, v92, v93
    v_cvt_pk_bf16_f32 v47, v94, v95
    s_nop 1
    s_waitcnt lgkmcnt(14)
    v_mfma_f32_32x32x16_bf16 v[160:175], v[128:131], v[40:43], v[160:175]
    s_waitcnt lgkmcnt(12)
    v_mfma_f32_32x32x16_bf16 v[176:191], v[132:135], v[40:43], v[176:191]
    s_waitcnt lgkmcnt(10)
    v_mfma_f32_32x32x16_bf16 v[192:207], v[136:139], v[40:43], v[192:207]
    s_waitcnt lgkmcnt(8)
    v_mfma_f32_32x32x16_bf16 v[208:223], v[140:143], v[40:43], v[208:223]
    s_waitcnt lgkmcnt(6)
    v_mfma_f32_32x32x16_bf16 v[160:175], v[144:147], v[44:47], v[160:175]
    s_waitcnt lgkmcnt(4)
    v_mfma_f32_32x32x16_bf16 v[176:191], v[148:151], v[44:47], v[176:191]
    s_waitcnt lgkmcnt(2)
    v_mfma_f32_32x32x16_bf16 v[192:207], v[152:155], v[44:47], v[192:207]
    s_waitcnt lgkmcnt(0)
    v_mfma_f32_32x32x16_bf16 v[208:223], v[156:159], v[44:47], v[208:223]
    s_waitcnt vmcnt(8)
    s_barrier
    s_add_u32 s25, s30, 32768
    s_mov_b32 m0, s25
    s_add_u32 s26, s24, 0
    buffer_load_dwordx4 v2, s[4:7], s26 offen nt lds
    s_add_u32 s25, s30, 33792
    s_mov_b32 m0, s25
    s_add_u32 s26, s24, 1024
    buffer_load_dwordx4 v3, s[4:7], s26 offen nt lds
    s_add_u32 s25, s30, 49152
    s_mov_b32 m0, s25
    s_add_u32 s26, s24, 0
    buffer_load_dwordx4 v4, s[8:11], s26 offen nt lds
    s_add_u32 s25, s30, 50176
    s_mov_b32 m0, s25
    s_add_u32 s26, s24, 1024
    buffer_load_dwordx4 v4, s[8:11], s26 offen nt lds
    s_add_u32 s24, s24, 16384
    ds_read_b128 v[96:99], v17 offset:0
    ds_read_b128 v[100:103], v18 offset:0
    ds_read_b128 v[104:107], v19 offset:0
    ds_read_b128 v[108:111], v20 offset:0
    ds_read_b128 v[112:115], v21 offset:0
    ds_read_b128 v[116:119], v22 offset:0
    ds_read_b128 v[120:123], v23 offset:0
    ds_read_b128 v[124:127], v24 offset:0
    s_waitcnt lgkmcnt(7)
    v_mfma_f32_32x32x16_bf16 v[80:95], v[96:99], v[48:51], 0
    s_waitcnt lgkmcnt(6)
    v_mfma_f32_32x32x16_bf16 v[80:95], v[100:103], v[52:55], v[80:95]
    s_waitcnt lgkmcnt(5)
    v_mfma_f32_32x32x16_bf16 v[80:95], v[104:107], v[56:59], v[80:95]
    s_waitcnt lgkmcnt(4)
    v_mfma_f32_32x32x16_bf16 v[80:95], v[108:111], v[60:63], v[80:95]
    s_waitcnt lgkmcnt(3)
    v_mfma_f32_32x32x16_bf16 v[80:95], v[112:115], v[64:67], v[80:95]
    s_waitcnt lgkmcnt(2)
    v_mfma_f32_32x32x16_bf16 v[80:95], v[116:119], v[68:71], v[80:95]
    s_waitcnt lgkmcnt(1)
    v_mfma_f32_32x32x16_bf16 v[80:95], v[120:123], v[72:75], v[80:95]
    s_waitcnt lgkmcnt(0)
    v_mfma_f32_32x32x16_bf16 v[80:95], v[124:127], v[76:79], v[80:95]
    ds_read_b64_tr_b16 v[128:129], v25 offset:0
    ds_read_b64_tr_b16 v[130:131], v25 offset:2048
    ds_read_b64_tr_b16 v[132:133], v26 offset:0
    ds_read_b64_tr_b16 v[134:135], v26 offset:2048
    ds_read_b64_tr_b16 v[136:137], v27 offset:0
    ds_read_b64_tr_b16 v[138:139], v27 offset:2048
    ds_read_b64_tr_b16 v[140:141], v28 offset:0
    ds_read_b64_tr_b16 v[142:143], v28 offset:2048
    ds_read_b64_tr_b16 v[144:145], v25 offset:4096
    ds_read_b64_tr_b16 v[146:147], v25 offset:6144
    ds_read_b64_tr_b16 v[148:149], v26 offset:4096
    ds_read_b64_tr_b16 v[150:151], v26 offset:6144
    ds_read_b64_tr_b16 v[152:153], v27 offset:4096
    ds_read_b64_tr_b16 v[154:155], v27 offset:6144
    ds_read_b64_tr_b16 v[156:157], v28 offset:4096
    ds_read_b64_tr_b16 v[158:159], v28 offset:6144
    s_nop 7
    s_nop 3
    v_max3_f32 v32, v80, v81, v82
    v_max3_f32 v33, v83, v84, v85
    v_max3_f32 v34, v86, v87, v88
    v_max3_f32 v35, v89, v90, v91
    v_max3_f32 v36, v92, v93, v94
    v_max3_f32 v32, v32, v33, v34
    v_max3_f32 v35, v35, v36, v95
    v_max_f32 v32, v32, v35
    v_mov_b32 v33, v32
    s_nop 1
    v_permlane32_swap_b32 v32, v33
    v_max_f32 v32, v32, v33
    v_mul_f32 v32, s28, v32
    v_max_f32 v33, v29, v32
    v_sub_f32 v34, v33, v29
    v_cmp_gt_f32 vcc, v34, s32
    s_cmp_lg_u64 vcc, 0
    s_cbranch_scc0 attn_kernel_skip9
    v_sub_f32 v34, v29, v33
    v_exp_f32 v31, v34
    v_mov_b32 v29, v33
    v_mul_f32 v30, v30, v31
    v_mul_f32 v160, v160, v31
    v_mul_f32 v161, v161, v31
    v_mul_f32 v162, v162, v31
    v_mul_f32 v163, v163, v31
    v_mul_f32 v164, v164, v31
    v_mul_f32 v165, v165, v31
    v_mul_f32 v166, v166, v31
    v_mul_f32 v167, v167, v31
    v_mul_f32 v168, v168, v31
    v_mul_f32 v169, v169, v31
    v_mul_f32 v170, v170, v31
    v_mul_f32 v171, v171, v31
    v_mul_f32 v172, v172, v31
    v_mul_f32 v173, v173, v31
    v_mul_f32 v174, v174, v31
    v_mul_f32 v175, v175, v31
    v_mul_f32 v176, v176, v31
    v_mul_f32 v177, v177, v31
    v_mul_f32 v178, v178, v31
    v_mul_f32 v179, v179, v31
    v_mul_f32 v180, v180, v31
    v_mul_f32 v181, v181, v31
    v_mul_f32 v182, v182, v31
    v_mul_f32 v183, v183, v31
    v_mul_f32 v184, v184, v31
    v_mul_f32 v185, v185, v31
    v_mul_f32 v186, v186, v31
    v_mul_f32 v187, v187, v31
    v_mul_f32 v188, v188, v31
    v_mul_f32 v189, v189, v31
    v_mul_f32 v190, v190, v31
    v_mul_f32 v191, v191, v31
    v_mul_f32 v192, v192, v31
    v_mul_f32 v193, v193, v31
    v_mul_f32 v194, v194, v31
    v_mul_f32 v195, v195, v31
    v_mul_f32 v196, v196, v31
    v_mul_f32 v197, v197, v31
    v_mul_f32 v198, v198, v31
    v_mul_f32 v199, v199, v31
    v_mul_f32 v200, v200, v31
    v_mul_f32 v201, v201, v31
    v_mul_f32 v202, v202, v31
    v_mul_f32 v203, v203, v31
    v_mul_f32 v204, v204, v31
    v_mul_f32 v205, v205, v31
    v_mul_f32 v206, v206, v31
    v_mul_f32 v207, v207, v31
    v_mul_f32 v208, v208, v31
    v_mul_f32 v209, v209, v31
    v_mul_f32 v210, v210, v31
    v_mul_f32 v211, v211, v31
    v_mul_f32 v212, v212, v31
    v_mul_f32 v213, v213, v31
    v_mul_f32 v214, v214, v31
    v_mul_f32 v215, v215, v31
    v_mul_f32 v216, v216, v31
    v_mul_f32 v217, v217, v31
    v_mul_f32 v218, v218, v31
    v_mul_f32 v219, v219, v31
    v_mul_f32 v220, v220, v31
    v_mul_f32 v221, v221, v31
    v_mul_f32 v222, v222, v31
    v_mul_f32 v223, v223, v31
attn_kernel_skip9:
    v_fma_f32 v80, v80, s28, -v29
    v_fma_f32 v81, v81, s28, -v29
    v_fma_f32 v82, v82, s28, -v29
    v_fma_f32 v83, v83, s28, -v29
    v_fma_f32 v84, v84, s28, -v29
    v_fma_f32 v85, v85, s28, -v29
    v_fma_f32 v86, v86, s28, -v29
    v_fma_f32 v87, v87, s28, -v29
    v_fma_f32 v88, v88, s28, -v29
    v_fma_f32 v89, v89, s28, -v29
    v_fma_f32 v90, v90, s28, -v29
    v_fma_f32 v91, v91, s28, -v29
    v_fma_f32 v92, v92, s28, -v29
    v_fma_f32 v93, v93, s28, -v29
    v_fma_f32 v94, v94, s28, -v29
    v_fma_f32 v95, v95, s28, -v29
    v_exp_f32 v80, v80
    v_exp_f32 v81, v81
    v_exp_f32 v82, v82
    v_exp_f32 v83, v83
    v_exp_f32 v84, v84
    v_exp_f32 v85, v85
    v_exp_f32 v86, v86
    v_exp_f32 v87, v87
    v_exp_f32 v88, v88
    v_exp_f32 v89, v89
    v_exp_f32 v90, v90
    v_exp_f32 v91, v91
    v_exp_f32 v92, v92
    v_exp_f32 v93, v93
    v_exp_f32 v94, v94
    v_exp_f32 v95, v95
    v_add_f32 v34, v80, v81
    v_add_f32 v30, v30, v34
    v_add_f32 v34, v82, v83
    v_add_f32 v30, v30, v34
    v_add_f32 v34, v84, v85
    v_add_f32 v30, v30, v34
    v_add_f32 v34, v86, v87
    v_add_f32 v30, v30, v34
    v_add_f32 v34, v88, v89
    v_add_f32 v30, v30, v34
    v_add_f32 v34, v90, v91
    v_add_f32 v30, v30, v34
    v_add_f32 v34, v92, v93
    v_add_f32 v30, v30, v34
    v_add_f32 v34, v94, v95
    v_add_f32 v30, v30, v34
    v_cvt_pk_bf16_f32 v40, v80, v81
    v_cvt_pk_bf16_f32 v41, v82, v83
    v_cvt_pk_bf16_f32 v42, v84, v85
    v_cvt_pk_bf16_f32 v43, v86, v87
    v_cvt_pk_bf16_f32 v44, v88, v89
    v_cvt_pk_bf16_f32 v45, v90, v91
    v_cvt_pk_bf16_f32 v46, v92, v93
    v_cvt_pk_bf16_f32 v47, v94, v95
    s_nop 1
    s_waitcnt lgkmcnt(14)
    v_mfma_f32_32x32x16_bf16 v[160:175], v[128:131], v[40:43], v[160:175]
    s_waitcnt lgkmcnt(12)
    v_mfma_f32_32x32x16_bf16 v[176:191], v[132:135], v[40:43], v[176:191]
    s_waitcnt lgkmcnt(10)
    v_mfma_f32_32x32x16_bf16 v[192:207], v[136:139], v[40:43], v[192:207]
    s_waitcnt lgkmcnt(8)
    v_mfma_f32_32x32x16_bf16 v[208:223], v[140:143], v[40:43], v[208:223]
    s_waitcnt lgkmcnt(6)
    v_mfma_f32_32x32x16_bf16 v[160:175], v[144:147], v[44:47], v[160:175]
    s_waitcnt lgkmcnt(4)
    v_mfma_f32_32x32x16_bf16 v[176:191], v[148:151], v[44:47], v[176:191]
    s_waitcnt lgkmcnt(2)
    v_mfma_f32_32x32x16_bf16 v[192:207], v[152:155], v[44:47], v[192:207]
    s_waitcnt lgkmcnt(0)
    v_mfma_f32_32x32x16_bf16 v[208:223], v[156:159], v[44:47], v[208:223]
    s_waitcnt vmcnt(8)
    s_barrier
    s_add_u32 s25, s30, 65536
    s_mov_b32 m0, s25
    s_add_u32 s26, s24, 0
    buffer_load_dwordx4 v2, s[4:7], s26 offen nt lds
    s_add_u32 s25, s30, 66560
    s_mov_b32 m0, s25
    s_add_u32 s26, s24, 1024
    buffer_load_dwordx4 v3, s[4:7], s26 offen nt lds
    s_add_u32 s25, s30, 81920
    s_mov_b32 m0, s25
    s_add_u32 s26, s24, 0
    buffer_load_dwordx4 v4, s[8:11], s26 offen nt lds
    s_add_u32 s25, s30, 82944
    s_mov_b32 m0, s25
    s_add_u32 s26, s24, 1024
    buffer_load_dwordx4 v4, s[8:11], s26 offen nt lds
    s_add_u32 s24, s24, 16384
    ds_read_b128 v[96:99], v17 offset:32768
    ds_read_b128 v[100:103], v18 offset:32768
    ds_read_b128 v[104:107], v19 offset:32768
    ds_read_b128 v[108:111], v20 offset:32768
    ds_read_b128 v[112:115], v21 offset:32768
    ds_read_b128 v[116:119], v22 offset:32768
    ds_read_b128 v[120:123], v23 offset:32768
    ds_read_b128 v[124:127], v24 offset:32768
    s_waitcnt lgkmcnt(7)
    v_mfma_f32_32x32x16_bf16 v[80:95], v[96:99], v[48:51], 0
    s_waitcnt lgkmcnt(6)
    v_mfma_f32_32x32x16_bf16 v[80:95], v[100:103], v[52:55], v[80:95]
    s_waitcnt lgkmcnt(5)
    v_mfma_f32_32x32x16_bf16 v[80:95], v[104:107], v[56:59], v[80:95]
    s_waitcnt lgkmcnt(4)
    v_mfma_f32_32x32x16_bf16 v[80:95], v[108:111], v[60:63], v[80:95]
    s_waitcnt lgkmcnt(3)
    v_mfma_f32_32x32x16_bf16 v[80:95], v[112:115], v[64:67], v[80:95]
    s_waitcnt lgkmcnt(2)
    v_mfma_f32_32x32x16_bf16 v[80:95], v[116:119], v[68:71], v[80:95]
    s_waitcnt lgkmcnt(1)
    v_mfma_f32_32x32x16_bf16 v[80:95], v[120:123], v[72:75], v[80:95]
    s_waitcnt lgkmcnt(0)
    v_mfma_f32_32x32x16_bf16 v[80:95], v[124:127], v[76:79], v[80:95]
    ds_read_b64_tr_b16 v[128:129], v25 offset:32768
    ds_read_b64_tr_b16 v[130:131], v25 offset:34816
    ds_read_b64_tr_b16 v[132:133], v26 offset:32768
    ds_read_b64_tr_b16 v[134:135], v26 offset:34816
    ds_read_b64_tr_b16 v[136:137], v27 offset:32768
    ds_read_b64_tr_b16 v[138:139], v27 offset:34816
    ds_read_b64_tr_b16 v[140:141], v28 offset:32768
    ds_read_b64_tr_b16 v[142:143], v28 offset:34816
    ds_read_b64_tr_b16 v[144:145], v25 offset:36864
    ds_read_b64_tr_b16 v[146:147], v25 offset:38912
    ds_read_b64_tr_b16 v[148:149], v26 offset:36864
    ds_read_b64_tr_b16 v[150:151], v26 offset:38912
    ds_read_b64_tr_b16 v[152:153], v27 offset:36864
    ds_read_b64_tr_b16 v[154:155], v27 offset:38912
    ds_read_b64_tr_b16 v[156:157], v28 offset:36864
    ds_read_b64_tr_b16 v[158:159], v28 offset:38912
    s_nop 7
    s_nop 3
    v_max3_f32 v32, v80, v81, v82
    v_max3_f32 v33, v83, v84, v85
    v_max3_f32 v34, v86, v87, v88
    v_max3_f32 v35, v89, v90, v91
    v_max3_f32 v36, v92, v93, v94
    v_max3_f32 v32, v32, v33, v34
    v_max3_f32 v35, v35, v36, v95
    v_max_f32 v32, v32, v35
    v_mov_b32 v33, v32
    s_nop 1
    v_permlane32_swap_b32 v32, v33
    v_max_f32 v32, v32, v33
    v_mul_f32 v32, s28, v32
    v_max_f32 v33, v29, v32
    v_sub_f32 v34, v33, v29
    v_cmp_gt_f32 vcc, v34, s32
    s_cmp_lg_u64 vcc, 0
    s_cbranch_scc0 attn_kernel_skip10
    v_sub_f32 v34, v29, v33
    v_exp_f32 v31, v34
    v_mov_b32 v29, v33
    v_mul_f32 v30, v30, v31
    v_mul_f32 v160, v160, v31
    v_mul_f32 v161, v161, v31
    v_mul_f32 v162, v162, v31
    v_mul_f32 v163, v163, v31
    v_mul_f32 v164, v164, v31
    v_mul_f32 v165, v165, v31
    v_mul_f32 v166, v166, v31
    v_mul_f32 v167, v167, v31
    v_mul_f32 v168, v168, v31
    v_mul_f32 v169, v169, v31
    v_mul_f32 v170, v170, v31
    v_mul_f32 v171, v171, v31
    v_mul_f32 v172, v172, v31
    v_mul_f32 v173, v173, v31
    v_mul_f32 v174, v174, v31
    v_mul_f32 v175, v175, v31
    v_mul_f32 v176, v176, v31
    v_mul_f32 v177, v177, v31
    v_mul_f32 v178, v178, v31
    v_mul_f32 v179, v179, v31
    v_mul_f32 v180, v180, v31
    v_mul_f32 v181, v181, v31
    v_mul_f32 v182, v182, v31
    v_mul_f32 v183, v183, v31
    v_mul_f32 v184, v184, v31
    v_mul_f32 v185, v185, v31
    v_mul_f32 v186, v186, v31
    v_mul_f32 v187, v187, v31
    v_mul_f32 v188, v188, v31
    v_mul_f32 v189, v189, v31
    v_mul_f32 v190, v190, v31
    v_mul_f32 v191, v191, v31
    v_mul_f32 v192, v192, v31
    v_mul_f32 v193, v193, v31
    v_mul_f32 v194, v194, v31
    v_mul_f32 v195, v195, v31
    v_mul_f32 v196, v196, v31
    v_mul_f32 v197, v197, v31
    v_mul_f32 v198, v198, v31
    v_mul_f32 v199, v199, v31
    v_mul_f32 v200, v200, v31
    v_mul_f32 v201, v201, v31
    v_mul_f32 v202, v202, v31
    v_mul_f32 v203, v203, v31
    v_mul_f32 v204, v204, v31
    v_mul_f32 v205, v205, v31
    v_mul_f32 v206, v206, v31
    v_mul_f32 v207, v207, v31
    v_mul_f32 v208, v208, v31
    v_mul_f32 v209, v209, v31
    v_mul_f32 v210, v210, v31
    v_mul_f32 v211, v211, v31
    v_mul_f32 v212, v212, v31
    v_mul_f32 v213, v213, v31
    v_mul_f32 v214, v214, v31
    v_mul_f32 v215, v215, v31
    v_mul_f32 v216, v216, v31
    v_mul_f32 v217, v217, v31
    v_mul_f32 v218, v218, v31
    v_mul_f32 v219, v219, v31
    v_mul_f32 v220, v220, v31
    v_mul_f32 v221, v221, v31
    v_mul_f32 v222, v222, v31
    v_mul_f32 v223, v223, v31
attn_kernel_skip10:
    v_fma_f32 v80, v80, s28, -v29
    v_fma_f32 v81, v81, s28, -v29
    v_fma_f32 v82, v82, s28, -v29
    v_fma_f32 v83, v83, s28, -v29
    v_fma_f32 v84, v84, s28, -v29
    v_fma_f32 v85, v85, s28, -v29
    v_fma_f32 v86, v86, s28, -v29
    v_fma_f32 v87, v87, s28, -v29
    v_fma_f32 v88, v88, s28, -v29
    v_fma_f32 v89, v89, s28, -v29
    v_fma_f32 v90, v90, s28, -v29
    v_fma_f32 v91, v91, s28, -v29
    v_fma_f32 v92, v92, s28, -v29
    v_fma_f32 v93, v93, s28, -v29
    v_fma_f32 v94, v94, s28, -v29
    v_fma_f32 v95, v95, s28, -v29
    v_exp_f32 v80, v80
    v_exp_f32 v81, v81
    v_exp_f32 v82, v82
    v_exp_f32 v83, v83
    v_exp_f32 v84, v84
    v_exp_f32 v85, v85
    v_exp_f32 v86, v86
    v_exp_f32 v87, v87
    v_exp_f32 v88, v88
    v_exp_f32 v89, v89
    v_exp_f32 v90, v90
    v_exp_f32 v91, v91
    v_exp_f32 v92, v92
    v_exp_f32 v93, v93
    v_exp_f32 v94, v94
    v_exp_f32 v95, v95
    v_add_f32 v34, v80, v81
    v_add_f32 v30, v30, v34
    v_add_f32 v34, v82, v83
    v_add_f32 v30, v30, v34
    v_add_f32 v34, v84, v85
    v_add_f32 v30, v30, v34
    v_add_f32 v34, v86, v87
    v_add_f32 v30, v30, v34
    v_add_f32 v34, v88, v89
    v_add_f32 v30, v30, v34
    v_add_f32 v34, v90, v91
    v_add_f32 v30, v30, v34
    v_add_f32 v34, v92, v93
    v_add_f32 v30, v30, v34
    v_add_f32 v34, v94, v95
    v_add_f32 v30, v30, v34
    v_cvt_pk_bf16_f32 v40, v80, v81
    v_cvt_pk_bf16_f32 v41, v82, v83
    v_cvt_pk_bf16_f32 v42, v84, v85
    v_cvt_pk_bf16_f32 v43, v86, v87
    v_cvt_pk_bf16_f32 v44, v88, v89
    v_cvt_pk_bf16_f32 v45, v90, v91
    v_cvt_pk_bf16_f32 v46, v92, v93
    v_cvt_pk_bf16_f32 v47, v94, v95
    s_nop 1
    s_waitcnt lgkmcnt(14)
    v_mfma_f32_32x32x16_bf16 v[160:175], v[128:131], v[40:43], v[160:175]
    s_waitcnt lgkmcnt(12)
    v_mfma_f32_32x32x16_bf16 v[176:191], v[132:135], v[40:43], v[176:191]
    s_waitcnt lgkmcnt(10)
    v_mfma_f32_32x32x16_bf16 v[192:207], v[136:139], v[40:43], v[192:207]
    s_waitcnt lgkmcnt(8)
    v_mfma_f32_32x32x16_bf16 v[208:223], v[140:143], v[40:43], v[208:223]
    s_waitcnt lgkmcnt(6)
    v_mfma_f32_32x32x16_bf16 v[160:175], v[144:147], v[44:47], v[160:175]
    s_waitcnt lgkmcnt(4)
    v_mfma_f32_32x32x16_bf16 v[176:191], v[148:151], v[44:47], v[176:191]
    s_waitcnt lgkmcnt(2)
    v_mfma_f32_32x32x16_bf16 v[192:207], v[152:155], v[44:47], v[192:207]
    s_waitcnt lgkmcnt(0)
    v_mfma_f32_32x32x16_bf16 v[208:223], v[156:159], v[44:47], v[208:223]
    s_waitcnt vmcnt(8)
    s_barrier
    s_add_u32 s25, s30, 98304
    s_mov_b32 m0, s25
    s_add_u32 s26, s24, 0
    buffer_load_dwordx4 v2, s[4:7], s26 offen nt lds
    s_add_u32 s25, s30, 99328
    s_mov_b32 m0, s25
    s_add_u32 s26, s24, 1024
    buffer_load_dwordx4 v3, s[4:7], s26 offen nt lds
    s_add_u32 s25, s30, 114688
    s_mov_b32 m0, s25
    s_add_u32 s26, s24, 0
    buffer_load_dwordx4 v4, s[8:11], s26 offen nt lds
    s_add_u32 s25, s30, 115712
    s_mov_b32 m0, s25
    s_add_u32 s26, s24, 1024
    buffer_load_dwordx4 v4, s[8:11], s26 offen nt lds
    s_add_u32 s24, s24, 16384
    ds_read_b128 v[96:99], v5 offset:0
    ds_read_b128 v[100:103], v6 offset:0
    ds_read_b128 v[104:107], v7 offset:0
    ds_read_b128 v[108:111], v8 offset:0
    ds_read_b128 v[112:115], v9 offset:0
    ds_read_b128 v[116:119], v10 offset:0
    ds_read_b128 v[120:123], v11 offset:0
    ds_read_b128 v[124:127], v12 offset:0
    s_waitcnt lgkmcnt(7)
    v_mfma_f32_32x32x16_bf16 v[80:95], v[96:99], v[48:51], 0
    s_waitcnt lgkmcnt(6)
    v_mfma_f32_32x32x16_bf16 v[80:95], v[100:103], v[52:55], v[80:95]
    s_waitcnt lgkmcnt(5)
    v_mfma_f32_32x32x16_bf16 v[80:95], v[104:107], v[56:59], v[80:95]
    s_waitcnt lgkmcnt(4)
    v_mfma_f32_32x32x16_bf16 v[80:95], v[108:111], v[60:63], v[80:95]
    s_waitcnt lgkmcnt(3)
    v_mfma_f32_32x32x16_bf16 v[80:95], v[112:115], v[64:67], v[80:95]
    s_waitcnt lgkmcnt(2)
    v_mfma_f32_32x32x16_bf16 v[80:95], v[116:119], v[68:71], v[80:95]
    s_waitcnt lgkmcnt(1)
    v_mfma_f32_32x32x16_bf16 v[80:95], v[120:123], v[72:75], v[80:95]
    s_waitcnt lgkmcnt(0)
    v_mfma_f32_32x32x16_bf16 v[80:95], v[124:127], v[76:79], v[80:95]
    ds_read_b64_tr_b16 v[128:129], v13 offset:0
    ds_read_b64_tr_b16 v[130:131], v13 offset:2048
    ds_read_b64_tr_b16 v[132:133], v14 offset:0
    ds_read_b64_tr_b16 v[134:135], v14 offset:2048
    ds_read_b64_tr_b16 v[136:137], v15 offset:0
    ds_read_b64_tr_b16 v[138:139], v15 offset:2048
    ds_read_b64_tr_b16 v[140:141], v16 offset:0
    ds_read_b64_tr_b16 v[142:143], v16 offset:2048
    ds_read_b64_tr_b16 v[144:145], v13 offset:4096
    ds_read_b64_tr_b16 v[146:147], v13 offset:6144
    ds_read_b64_tr_b16 v[148:149], v14 offset:4096
    ds_read_b64_tr_b16 v[150:151], v14 offset:6144
    ds_read_b64_tr_b16 v[152:153], v15 offset:4096
    ds_read_b64_tr_b16 v[154:155], v15 offset:6144
    ds_read_b64_tr_b16 v[156:157], v16 offset:4096
    ds_read_b64_tr_b16 v[158:159], v16 offset:6144
    s_nop 7
    s_nop 3
    v_max3_f32 v32, v80, v81, v82
    v_max3_f32 v33, v83, v84, v85
    v_max3_f32 v34, v86, v87, v88
    v_max3_f32 v35, v89, v90, v91
    v_max3_f32 v36, v92, v93, v94
    v_max3_f32 v32, v32, v33, v34
    v_max3_f32 v35, v35, v36, v95
    v_max_f32 v32, v32, v35
    v_mov_b32 v33, v32
    s_nop 1
    v_permlane32_swap_b32 v32, v33
    v_max_f32 v32, v32, v33
    v_mul_f32 v32, s28, v32
    v_max_f32 v33, v29, v32
    v_sub_f32 v34, v33, v29
    v_cmp_gt_f32 vcc, v34, s32
    s_cmp_lg_u64 vcc, 0
    s_cbranch_scc0 attn_kernel_skip11
    v_sub_f32 v34, v29, v33
    v_exp_f32 v31, v34
    v_mov_b32 v29, v33
    v_mul_f32 v30, v30, v31
    v_mul_f32 v160, v160, v31
    v_mul_f32 v161, v161, v31
    v_mul_f32 v162, v162, v31
    v_mul_f32 v163, v163, v31
    v_mul_f32 v164, v164, v31
    v_mul_f32 v165, v165, v31
    v_mul_f32 v166, v166, v31
    v_mul_f32 v167, v167, v31
    v_mul_f32 v168, v168, v31
    v_mul_f32 v169, v169, v31
    v_mul_f32 v170, v170, v31
    v_mul_f32 v171, v171, v31
    v_mul_f32 v172, v172, v31
    v_mul_f32 v173, v173, v31
    v_mul_f32 v174, v174, v31
    v_mul_f32 v175, v175, v31
    v_mul_f32 v176, v176, v31
    v_mul_f32 v177, v177, v31
    v_mul_f32 v178, v178, v31
    v_mul_f32 v179, v179, v31
    v_mul_f32 v180, v180, v31
    v_mul_f32 v181, v181, v31
    v_mul_f32 v182, v182, v31
    v_mul_f32 v183, v183, v31
    v_mul_f32 v184, v184, v31
    v_mul_f32 v185, v185, v31
    v_mul_f32 v186, v186, v31
    v_mul_f32 v187, v187, v31
    v_mul_f32 v188, v188, v31
    v_mul_f32 v189, v189, v31
    v_mul_f32 v190, v190, v31
    v_mul_f32 v191, v191, v31
    v_mul_f32 v192, v192, v31
    v_mul_f32 v193, v193, v31
    v_mul_f32 v194, v194, v31
    v_mul_f32 v195, v195, v31
    v_mul_f32 v196, v196, v31
    v_mul_f32 v197, v197, v31
    v_mul_f32 v198, v198, v31
    v_mul_f32 v199, v199, v31
    v_mul_f32 v200, v200, v31
    v_mul_f32 v201, v201, v31
    v_mul_f32 v202, v202, v31
    v_mul_f32 v203, v203, v31
    v_mul_f32 v204, v204, v31
    v_mul_f32 v205, v205, v31
    v_mul_f32 v206, v206, v31
    v_mul_f32 v207, v207, v31
    v_mul_f32 v208, v208, v31
    v_mul_f32 v209, v209, v31
    v_mul_f32 v210, v210, v31
    v_mul_f32 v211, v211, v31
    v_mul_f32 v212, v212, v31
    v_mul_f32 v213, v213, v31
    v_mul_f32 v214, v214, v31
    v_mul_f32 v215, v215, v31
    v_mul_f32 v216, v216, v31
    v_mul_f32 v217, v217, v31
    v_mul_f32 v218, v218, v31
    v_mul_f32 v219, v219, v31
    v_mul_f32 v220, v220, v31
    v_mul_f32 v221, v221, v31
    v_mul_f32 v222, v222, v31
    v_mul_f32 v223, v223, v31
attn_kernel_skip11:
    v_fma_f32 v80, v80, s28, -v29
    v_fma_f32 v81, v81, s28, -v29
    v_fma_f32 v82, v82, s28, -v29
    v_fma_f32 v83, v83, s28, -v29
    v_fma_f32 v84, v84, s28, -v29
    v_fma_f32 v85, v85, s28, -v29
    v_fma_f32 v86, v86, s28, -v29
    v_fma_f32 v87, v87, s28, -v29
    v_fma_f32 v88, v88, s28, -v29
    v_fma_f32 v89, v89, s28, -v29
    v_fma_f32 v90, v90, s28, -v29
    v_fma_f32 v91, v91, s28, -v29
    v_fma_f32 v92, v92, s28, -v29
    v_fma_f32 v93, v93, s28, -v29
    v_fma_f32 v94, v94, s28, -v29
    v_fma_f32 v95, v95, s28, -v29
    v_exp_f32 v80, v80
    v_exp_f32 v81, v81
    v_exp_f32 v82, v82
    v_exp_f32 v83, v83
    v_exp_f32 v84, v84
    v_exp_f32 v85, v85
    v_exp_f32 v86, v86
    v_exp_f32 v87, v87
    v_exp_f32 v88, v88
    v_exp_f32 v89, v89
    v_exp_f32 v90, v90
    v_exp_f32 v91, v91
    v_exp_f32 v92, v92
    v_exp_f32 v93, v93
    v_exp_f32 v94, v94
    v_exp_f32 v95, v95
    v_add_f32 v34, v80, v81
    v_add_f32 v30, v30, v34
    v_add_f32 v34, v82, v83
    v_add_f32 v30, v30, v34
    v_add_f32 v34, v84, v85
    v_add_f32 v30, v30, v34
    v_add_f32 v34, v86, v87
    v_add_f32 v30, v30, v34
    v_add_f32 v34, v88, v89
    v_add_f32 v30, v30, v34
    v_add_f32 v34, v90, v91
    v_add_f32 v30, v30, v34
    v_add_f32 v34, v92, v93
    v_add_f32 v30, v30, v34
    v_add_f32 v34, v94, v95
    v_add_f32 v30, v30, v34
    v_cvt_pk_bf16_f32 v40, v80, v81
    v_cvt_pk_bf16_f32 v41, v82, v83
    v_cvt_pk_bf16_f32 v42, v84, v85
    v_cvt_pk_bf16_f32 v43, v86, v87
    v_cvt_pk_bf16_f32 v44, v88, v89
    v_cvt_pk_bf16_f32 v45, v90, v91
    v_cvt_pk_bf16_f32 v46, v92, v93
    v_cvt_pk_bf16_f32 v47, v94, v95
    s_nop 1
    s_waitcnt lgkmcnt(14)
    v_mfma_f32_32x32x16_bf16 v[160:175], v[128:131], v[40:43], v[160:175]
    s_waitcnt lgkmcnt(12)
    v_mfma_f32_32x32x16_bf16 v[176:191], v[132:135], v[40:43], v[176:191]
    s_waitcnt lgkmcnt(10)
    v_mfma_f32_32x32x16_bf16 v[192:207], v[136:139], v[40:43], v[192:207]
    s_waitcnt lgkmcnt(8)
    v_mfma_f32_32x32x16_bf16 v[208:223], v[140:143], v[40:43], v[208:223]
    s_waitcnt lgkmcnt(6)
    v_mfma_f32_32x32x16_bf16 v[160:175], v[144:147], v[44:47], v[160:175]
    s_waitcnt lgkmcnt(4)
    v_mfma_f32_32x32x16_bf16 v[176:191], v[148:151], v[44:47], v[176:191]
    s_waitcnt lgkmcnt(2)
    v_mfma_f32_32x32x16_bf16 v[192:207], v[152:155], v[44:47], v[192:207]
    s_waitcnt lgkmcnt(0)
    v_mfma_f32_32x32x16_bf16 v[208:223], v[156:159], v[44:47], v[208:223]
    s_waitcnt vmcnt(8)
    s_barrier
    s_add_u32 s25, s30, 0
    s_mov_b32 m0, s25
    s_add_u32 s26, s24, 0
    buffer_load_dwordx4 v2, s[4:7], s26 offen nt lds
    s_add_u32 s25, s30, 1024
    s_mov_b32 m0, s25
    s_add_u32 s26, s24, 1024
    buffer_load_dwordx4 v3, s[4:7], s26 offen nt lds
    s_add_u32 s25, s30, 16384
    s_mov_b32 m0, s25
    s_add_u32 s26, s24, 0
    buffer_load_dwordx4 v4, s[8:11], s26 offen nt lds
    s_add_u32 s25, s30, 17408
    s_mov_b32 m0, s25
    s_add_u32 s26, s24, 1024
    buffer_load_dwordx4 v4, s[8:11], s26 offen nt lds
    s_add_u32 s24, s24, 16384
    ds_read_b128 v[96:99], v5 offset:32768
    ds_read_b128 v[100:103], v6 offset:32768
    ds_read_b128 v[104:107], v7 offset:32768
    ds_read_b128 v[108:111], v8 offset:32768
    ds_read_b128 v[112:115], v9 offset:32768
    ds_read_b128 v[116:119], v10 offset:32768
    ds_read_b128 v[120:123], v11 offset:32768
    ds_read_b128 v[124:127], v12 offset:32768
    s_waitcnt lgkmcnt(7)
    v_mfma_f32_32x32x16_bf16 v[80:95], v[96:99], v[48:51], 0
    s_waitcnt lgkmcnt(6)
    v_mfma_f32_32x32x16_bf16 v[80:95], v[100:103], v[52:55], v[80:95]
    s_waitcnt lgkmcnt(5)
    v_mfma_f32_32x32x16_bf16 v[80:95], v[104:107], v[56:59], v[80:95]
    s_waitcnt lgkmcnt(4)
    v_mfma_f32_32x32x16_bf16 v[80:95], v[108:111], v[60:63], v[80:95]
    s_waitcnt lgkmcnt(3)
    v_mfma_f32_32x32x16_bf16 v[80:95], v[112:115], v[64:67], v[80:95]
    s_waitcnt lgkmcnt(2)
    v_mfma_f32_32x32x16_bf16 v[80:95], v[116:119], v[68:71], v[80:95]
    s_waitcnt lgkmcnt(1)
    v_mfma_f32_32x32x16_bf16 v[80:95], v[120:123], v[72:75], v[80:95]
    s_waitcnt lgkmcnt(0)
    v_mfma_f32_32x32x16_bf16 v[80:95], v[124:127], v[76:79], v[80:95]
    ds_read_b64_tr_b16 v[128:129], v13 offset:32768
    ds_read_b64_tr_b16 v[130:131], v13 offset:34816
    ds_read_b64_tr_b16 v[132:133], v14 offset:32768
    ds_read_b64_tr_b16 v[134:135], v14 offset:34816
    ds_read_b64_tr_b16 v[136:137], v15 offset:32768
    ds_read_b64_tr_b16 v[138:139], v15 offset:34816
    ds_read_b64_tr_b16 v[140:141], v16 offset:32768
    ds_read_b64_tr_b16 v[142:143], v16 offset:34816
    ds_read_b64_tr_b16 v[144:145], v13 offset:36864
    ds_read_b64_tr_b16 v[146:147], v13 offset:38912
    ds_read_b64_tr_b16 v[148:149], v14 offset:36864
    ds_read_b64_tr_b16 v[150:151], v14 offset:38912
    ds_read_b64_tr_b16 v[152:153], v15 offset:36864
    ds_read_b64_tr_b16 v[154:155], v15 offset:38912
    ds_read_b64_tr_b16 v[156:157], v16 offset:36864
    ds_read_b64_tr_b16 v[158:159], v16 offset:38912
    s_nop 7
    s_nop 3
    v_max3_f32 v32, v80, v81, v82
    v_max3_f32 v33, v83, v84, v85
    v_max3_f32 v34, v86, v87, v88
    v_max3_f32 v35, v89, v90, v91
    v_max3_f32 v36, v92, v93, v94
    v_max3_f32 v32, v32, v33, v34
    v_max3_f32 v35, v35, v36, v95
    v_max_f32 v32, v32, v35
    v_mov_b32 v33, v32
    s_nop 1
    v_permlane32_swap_b32 v32, v33
    v_max_f32 v32, v32, v33
    v_mul_f32 v32, s28, v32
    v_max_f32 v33, v29, v32
    v_sub_f32 v34, v33, v29
    v_cmp_gt_f32 vcc, v34, s32
    s_cmp_lg_u64 vcc, 0
    s_cbranch_scc0 attn_kernel_skip12
    v_sub_f32 v34, v29, v33
    v_exp_f32 v31, v34
    v_mov_b32 v29, v33
    v_mul_f32 v30, v30, v31
    v_mul_f32 v160, v160, v31
    v_mul_f32 v161, v161, v31
    v_mul_f32 v162, v162, v31
    v_mul_f32 v163, v163, v31
    v_mul_f32 v164, v164, v31
    v_mul_f32 v165, v165, v31
    v_mul_f32 v166, v166, v31
    v_mul_f32 v167, v167, v31
    v_mul_f32 v168, v168, v31
    v_mul_f32 v169, v169, v31
    v_mul_f32 v170, v170, v31
    v_mul_f32 v171, v171, v31
    v_mul_f32 v172, v172, v31
    v_mul_f32 v173, v173, v31
    v_mul_f32 v174, v174, v31
    v_mul_f32 v175, v175, v31
    v_mul_f32 v176, v176, v31
    v_mul_f32 v177, v177, v31
    v_mul_f32 v178, v178, v31
    v_mul_f32 v179, v179, v31
    v_mul_f32 v180, v180, v31
    v_mul_f32 v181, v181, v31
    v_mul_f32 v182, v182, v31
    v_mul_f32 v183, v183, v31
    v_mul_f32 v184, v184, v31
    v_mul_f32 v185, v185, v31
    v_mul_f32 v186, v186, v31
    v_mul_f32 v187, v187, v31
    v_mul_f32 v188, v188, v31
    v_mul_f32 v189, v189, v31
    v_mul_f32 v190, v190, v31
    v_mul_f32 v191, v191, v31
    v_mul_f32 v192, v192, v31
    v_mul_f32 v193, v193, v31
    v_mul_f32 v194, v194, v31
    v_mul_f32 v195, v195, v31
    v_mul_f32 v196, v196, v31
    v_mul_f32 v197, v197, v31
    v_mul_f32 v198, v198, v31
    v_mul_f32 v199, v199, v31
    v_mul_f32 v200, v200, v31
    v_mul_f32 v201, v201, v31
    v_mul_f32 v202, v202, v31
    v_mul_f32 v203, v203, v31
    v_mul_f32 v204, v204, v31
    v_mul_f32 v205, v205, v31
    v_mul_f32 v206, v206, v31
    v_mul_f32 v207, v207, v31
    v_mul_f32 v208, v208, v31
    v_mul_f32 v209, v209, v31
    v_mul_f32 v210, v210, v31
    v_mul_f32 v211, v211, v31
    v_mul_f32 v212, v212, v31
    v_mul_f32 v213, v213, v31
    v_mul_f32 v214, v214, v31
    v_mul_f32 v215, v215, v31
    v_mul_f32 v216, v216, v31
    v_mul_f32 v217, v217, v31
    v_mul_f32 v218, v218, v31
    v_mul_f32 v219, v219, v31
    v_mul_f32 v220, v220, v31
    v_mul_f32 v221, v221, v31
    v_mul_f32 v222, v222, v31
    v_mul_f32 v223, v223, v31
attn_kernel_skip12:
    v_fma_f32 v80, v80, s28, -v29
    v_fma_f32 v81, v81, s28, -v29
    v_fma_f32 v82, v82, s28, -v29
    v_fma_f32 v83, v83, s28, -v29
    v_fma_f32 v84, v84, s28, -v29
    v_fma_f32 v85, v85, s28, -v29
    v_fma_f32 v86, v86, s28, -v29
    v_fma_f32 v87, v87, s28, -v29
    v_fma_f32 v88, v88, s28, -v29
    v_fma_f32 v89, v89, s28, -v29
    v_fma_f32 v90, v90, s28, -v29
    v_fma_f32 v91, v91, s28, -v29
    v_fma_f32 v92, v92, s28, -v29
    v_fma_f32 v93, v93, s28, -v29
    v_fma_f32 v94, v94, s28, -v29
    v_fma_f32 v95, v95, s28, -v29
    v_exp_f32 v80, v80
    v_exp_f32 v81, v81
    v_exp_f32 v82, v82
    v_exp_f32 v83, v83
    v_exp_f32 v84, v84
    v_exp_f32 v85, v85
    v_exp_f32 v86, v86
    v_exp_f32 v87, v87
    v_exp_f32 v88, v88
    v_exp_f32 v89, v89
    v_exp_f32 v90, v90
    v_exp_f32 v91, v91
    v_exp_f32 v92, v92
    v_exp_f32 v93, v93
    v_exp_f32 v94, v94
    v_exp_f32 v95, v95
    v_add_f32 v34, v80, v81
    v_add_f32 v30, v30, v34
    v_add_f32 v34, v82, v83
    v_add_f32 v30, v30, v34
    v_add_f32 v34, v84, v85
    v_add_f32 v30, v30, v34
    v_add_f32 v34, v86, v87
    v_add_f32 v30, v30, v34
    v_add_f32 v34, v88, v89
    v_add_f32 v30, v30, v34
    v_add_f32 v34, v90, v91
    v_add_f32 v30, v30, v34
    v_add_f32 v34, v92, v93
    v_add_f32 v30, v30, v34
    v_add_f32 v34, v94, v95
    v_add_f32 v30, v30, v34
    v_cvt_pk_bf16_f32 v40, v80, v81
    v_cvt_pk_bf16_f32 v41, v82, v83
    v_cvt_pk_bf16_f32 v42, v84, v85
    v_cvt_pk_bf16_f32 v43, v86, v87
    v_cvt_pk_bf16_f32 v44, v88, v89
    v_cvt_pk_bf16_f32 v45, v90, v91
    v_cvt_pk_bf16_f32 v46, v92, v93
    v_cvt_pk_bf16_f32 v47, v94, v95
    s_nop 1
    s_waitcnt lgkmcnt(14)
    v_mfma_f32_32x32x16_bf16 v[160:175], v[128:131], v[40:43], v[160:175]
    s_waitcnt lgkmcnt(12)
    v_mfma_f32_32x32x16_bf16 v[176:191], v[132:135], v[40:43], v[176:191]
    s_waitcnt lgkmcnt(10)
    v_mfma_f32_32x32x16_bf16 v[192:207], v[136:139], v[40:43], v[192:207]
    s_waitcnt lgkmcnt(8)
    v_mfma_f32_32x32x16_bf16 v[208:223], v[140:143], v[40:43], v[208:223]
    s_waitcnt lgkmcnt(6)
    v_mfma_f32_32x32x16_bf16 v[160:175], v[144:147], v[44:47], v[160:175]
    s_waitcnt lgkmcnt(4)
    v_mfma_f32_32x32x16_bf16 v[176:191], v[148:151], v[44:47], v[176:191]
    s_waitcnt lgkmcnt(2)
    v_mfma_f32_32x32x16_bf16 v[192:207], v[152:155], v[44:47], v[192:207]
    s_waitcnt lgkmcnt(0)
    v_mfma_f32_32x32x16_bf16 v[208:223], v[156:159], v[44:47], v[208:223]
    s_waitcnt vmcnt(8)
    s_barrier
    ds_read_b128 v[96:99], v17 offset:0
    ds_read_b128 v[100:103], v18 offset:0
    ds_read_b128 v[104:107], v19 offset:0
    ds_read_b128 v[108:111], v20 offset:0
    ds_read_b128 v[112:115], v21 offset:0
    ds_read_b128 v[116:119], v22 offset:0
    ds_read_b128 v[120:123], v23 offset:0
    ds_read_b128 v[124:127], v24 offset:0
    s_waitcnt lgkmcnt(7)
    v_mfma_f32_32x32x16_bf16 v[80:95], v[96:99], v[48:51], 0
    s_waitcnt lgkmcnt(6)
    v_mfma_f32_32x32x16_bf16 v[80:95], v[100:103], v[52:55], v[80:95]
    s_waitcnt lgkmcnt(5)
    v_mfma_f32_32x32x16_bf16 v[80:95], v[104:107], v[56:59], v[80:95]
    s_waitcnt lgkmcnt(4)
    v_mfma_f32_32x32x16_bf16 v[80:95], v[108:111], v[60:63], v[80:95]
    s_waitcnt lgkmcnt(3)
    v_mfma_f32_32x32x16_bf16 v[80:95], v[112:115], v[64:67], v[80:95]
    s_waitcnt lgkmcnt(2)
    v_mfma_f32_32x32x16_bf16 v[80:95], v[116:119], v[68:71], v[80:95]
    s_waitcnt lgkmcnt(1)
    v_mfma_f32_32x32x16_bf16 v[80:95], v[120:123], v[72:75], v[80:95]
    s_waitcnt lgkmcnt(0)
    v_mfma_f32_32x32x16_bf16 v[80:95], v[124:127], v[76:79], v[80:95]
    ds_read_b64_tr_b16 v[128:129], v25 offset:0
    ds_read_b64_tr_b16 v[130:131], v25 offset:2048
    ds_read_b64_tr_b16 v[132:133], v26 offset:0
    ds_read_b64_tr_b16 v[134:135], v26 offset:2048
    ds_read_b64_tr_b16 v[136:137], v27 offset:0
    ds_read_b64_tr_b16 v[138:139], v27 offset:2048
    ds_read_b64_tr_b16 v[140:141], v28 offset:0
    ds_read_b64_tr_b16 v[142:143], v28 offset:2048
    ds_read_b64_tr_b16 v[144:145], v25 offset:4096
    ds_read_b64_tr_b16 v[146:147], v25 offset:6144
    ds_read_b64_tr_b16 v[148:149], v26 offset:4096
    ds_read_b64_tr_b16 v[150:151], v26 offset:6144
    ds_read_b64_tr_b16 v[152:153], v27 offset:4096
    ds_read_b64_tr_b16 v[154:155], v27 offset:6144
    ds_read_b64_tr_b16 v[156:157], v28 offset:4096
    ds_read_b64_tr_b16 v[158:159], v28 offset:6144
    s_nop 7
    s_nop 3
    v_max3_f32 v32, v80, v81, v82
    v_max3_f32 v33, v83, v84, v85
    v_max3_f32 v34, v86, v87, v88
    v_max3_f32 v35, v89, v90, v91
    v_max3_f32 v36, v92, v93, v94
    v_max3_f32 v32, v32, v33, v34
    v_max3_f32 v35, v35, v36, v95
    v_max_f32 v32, v32, v35
    v_mov_b32 v33, v32
    s_nop 1
    v_permlane32_swap_b32 v32, v33
    v_max_f32 v32, v32, v33
    v_mul_f32 v32, s28, v32
    v_max_f32 v33, v29, v32
    v_sub_f32 v34, v33, v29
    v_cmp_gt_f32 vcc, v34, s32
    s_cmp_lg_u64 vcc, 0
    s_cbranch_scc0 attn_kernel_skip13
    v_sub_f32 v34, v29, v33
    v_exp_f32 v31, v34
    v_mov_b32 v29, v33
    v_mul_f32 v30, v30, v31
    v_mul_f32 v160, v160, v31
    v_mul_f32 v161, v161, v31
    v_mul_f32 v162, v162, v31
    v_mul_f32 v163, v163, v31
    v_mul_f32 v164, v164, v31
    v_mul_f32 v165, v165, v31
    v_mul_f32 v166, v166, v31
    v_mul_f32 v167, v167, v31
    v_mul_f32 v168, v168, v31
    v_mul_f32 v169, v169, v31
    v_mul_f32 v170, v170, v31
    v_mul_f32 v171, v171, v31
    v_mul_f32 v172, v172, v31
    v_mul_f32 v173, v173, v31
    v_mul_f32 v174, v174, v31
    v_mul_f32 v175, v175, v31
    v_mul_f32 v176, v176, v31
    v_mul_f32 v177, v177, v31
    v_mul_f32 v178, v178, v31
    v_mul_f32 v179, v179, v31
    v_mul_f32 v180, v180, v31
    v_mul_f32 v181, v181, v31
    v_mul_f32 v182, v182, v31
    v_mul_f32 v183, v183, v31
    v_mul_f32 v184, v184, v31
    v_mul_f32 v185, v185, v31
    v_mul_f32 v186, v186, v31
    v_mul_f32 v187, v187, v31
    v_mul_f32 v188, v188, v31
    v_mul_f32 v189, v189, v31
    v_mul_f32 v190, v190, v31
    v_mul_f32 v191, v191, v31
    v_mul_f32 v192, v192, v31
    v_mul_f32 v193, v193, v31
    v_mul_f32 v194, v194, v31
    v_mul_f32 v195, v195, v31
    v_mul_f32 v196, v196, v31
    v_mul_f32 v197, v197, v31
    v_mul_f32 v198, v198, v31
    v_mul_f32 v199, v199, v31
    v_mul_f32 v200, v200, v31
    v_mul_f32 v201, v201, v31
    v_mul_f32 v202, v202, v31
    v_mul_f32 v203, v203, v31
    v_mul_f32 v204, v204, v31
    v_mul_f32 v205, v205, v31
    v_mul_f32 v206, v206, v31
    v_mul_f32 v207, v207, v31
    v_mul_f32 v208, v208, v31
    v_mul_f32 v209, v209, v31
    v_mul_f32 v210, v210, v31
    v_mul_f32 v211, v211, v31
    v_mul_f32 v212, v212, v31
    v_mul_f32 v213, v213, v31
    v_mul_f32 v214, v214, v31
    v_mul_f32 v215, v215, v31
    v_mul_f32 v216, v216, v31
    v_mul_f32 v217, v217, v31
    v_mul_f32 v218, v218, v31
    v_mul_f32 v219, v219, v31
    v_mul_f32 v220, v220, v31
    v_mul_f32 v221, v221, v31
    v_mul_f32 v222, v222, v31
    v_mul_f32 v223, v223, v31
attn_kernel_skip13:
    v_fma_f32 v80, v80, s28, -v29
    v_fma_f32 v81, v81, s28, -v29
    v_fma_f32 v82, v82, s28, -v29
    v_fma_f32 v83, v83, s28, -v29
    v_fma_f32 v84, v84, s28, -v29
    v_fma_f32 v85, v85, s28, -v29
    v_fma_f32 v86, v86, s28, -v29
    v_fma_f32 v87, v87, s28, -v29
    v_fma_f32 v88, v88, s28, -v29
    v_fma_f32 v89, v89, s28, -v29
    v_fma_f32 v90, v90, s28, -v29
    v_fma_f32 v91, v91, s28, -v29
    v_fma_f32 v92, v92, s28, -v29
    v_fma_f32 v93, v93, s28, -v29
    v_fma_f32 v94, v94, s28, -v29
    v_fma_f32 v95, v95, s28, -v29
    v_exp_f32 v80, v80
    v_exp_f32 v81, v81
    v_exp_f32 v82, v82
    v_exp_f32 v83, v83
    v_exp_f32 v84, v84
    v_exp_f32 v85, v85
    v_exp_f32 v86, v86
    v_exp_f32 v87, v87
    v_exp_f32 v88, v88
    v_exp_f32 v89, v89
    v_exp_f32 v90, v90
    v_exp_f32 v91, v91
    v_exp_f32 v92, v92
    v_exp_f32 v93, v93
    v_exp_f32 v94, v94
    v_exp_f32 v95, v95
    v_add_f32 v34, v80, v81
    v_add_f32 v30, v30, v34
    v_add_f32 v34, v82, v83
    v_add_f32 v30, v30, v34
    v_add_f32 v34, v84, v85
    v_add_f32 v30, v30, v34
    v_add_f32 v34, v86, v87
    v_add_f32 v30, v30, v34
    v_add_f32 v34, v88, v89
    v_add_f32 v30, v30, v34
    v_add_f32 v34, v90, v91
    v_add_f32 v30, v30, v34
    v_add_f32 v34, v92, v93
    v_add_f32 v30, v30, v34
    v_add_f32 v34, v94, v95
    v_add_f32 v30, v30, v34
    v_cvt_pk_bf16_f32 v40, v80, v81
    v_cvt_pk_bf16_f32 v41, v82, v83
    v_cvt_pk_bf16_f32 v42, v84, v85
    v_cvt_pk_bf16_f32 v43, v86, v87
    v_cvt_pk_bf16_f32 v44, v88, v89
    v_cvt_pk_bf16_f32 v45, v90, v91
    v_cvt_pk_bf16_f32 v46, v92, v93
    v_cvt_pk_bf16_f32 v47, v94, v95
    s_nop 1
    s_waitcnt lgkmcnt(14)
    v_mfma_f32_32x32x16_bf16 v[160:175], v[128:131], v[40:43], v[160:175]
    s_waitcnt lgkmcnt(12)
    v_mfma_f32_32x32x16_bf16 v[176:191], v[132:135], v[40:43], v[176:191]
    s_waitcnt lgkmcnt(10)
    v_mfma_f32_32x32x16_bf16 v[192:207], v[136:139], v[40:43], v[192:207]
    s_waitcnt lgkmcnt(8)
    v_mfma_f32_32x32x16_bf16 v[208:223], v[140:143], v[40:43], v[208:223]
    s_waitcnt lgkmcnt(6)
    v_mfma_f32_32x32x16_bf16 v[160:175], v[144:147], v[44:47], v[160:175]
    s_waitcnt lgkmcnt(4)
    v_mfma_f32_32x32x16_bf16 v[176:191], v[148:151], v[44:47], v[176:191]
    s_waitcnt lgkmcnt(2)
    v_mfma_f32_32x32x16_bf16 v[192:207], v[152:155], v[44:47], v[192:207]
    s_waitcnt lgkmcnt(0)
    v_mfma_f32_32x32x16_bf16 v[208:223], v[156:159], v[44:47], v[208:223]
    s_waitcnt vmcnt(4)
    s_barrier
    ds_read_b128 v[96:99], v17 offset:32768
    ds_read_b128 v[100:103], v18 offset:32768
    ds_read_b128 v[104:107], v19 offset:32768
    ds_read_b128 v[108:111], v20 offset:32768
    ds_read_b128 v[112:115], v21 offset:32768
    ds_read_b128 v[116:119], v22 offset:32768
    ds_read_b128 v[120:123], v23 offset:32768
    ds_read_b128 v[124:127], v24 offset:32768
    s_waitcnt lgkmcnt(7)
    v_mfma_f32_32x32x16_bf16 v[80:95], v[96:99], v[48:51], 0
    s_waitcnt lgkmcnt(6)
    v_mfma_f32_32x32x16_bf16 v[80:95], v[100:103], v[52:55], v[80:95]
    s_waitcnt lgkmcnt(5)
    v_mfma_f32_32x32x16_bf16 v[80:95], v[104:107], v[56:59], v[80:95]
    s_waitcnt lgkmcnt(4)
    v_mfma_f32_32x32x16_bf16 v[80:95], v[108:111], v[60:63], v[80:95]
    s_waitcnt lgkmcnt(3)
    v_mfma_f32_32x32x16_bf16 v[80:95], v[112:115], v[64:67], v[80:95]
    s_waitcnt lgkmcnt(2)
    v_mfma_f32_32x32x16_bf16 v[80:95], v[116:119], v[68:71], v[80:95]
    s_waitcnt lgkmcnt(1)
    v_mfma_f32_32x32x16_bf16 v[80:95], v[120:123], v[72:75], v[80:95]
    s_waitcnt lgkmcnt(0)
    v_mfma_f32_32x32x16_bf16 v[80:95], v[124:127], v[76:79], v[80:95]
    ds_read_b64_tr_b16 v[128:129], v25 offset:32768
    ds_read_b64_tr_b16 v[130:131], v25 offset:34816
    ds_read_b64_tr_b16 v[132:133], v26 offset:32768
    ds_read_b64_tr_b16 v[134:135], v26 offset:34816
    ds_read_b64_tr_b16 v[136:137], v27 offset:32768
    ds_read_b64_tr_b16 v[138:139], v27 offset:34816
    ds_read_b64_tr_b16 v[140:141], v28 offset:32768
    ds_read_b64_tr_b16 v[142:143], v28 offset:34816
    ds_read_b64_tr_b16 v[144:145], v25 offset:36864
    ds_read_b64_tr_b16 v[146:147], v25 offset:38912
    ds_read_b64_tr_b16 v[148:149], v26 offset:36864
    ds_read_b64_tr_b16 v[150:151], v26 offset:38912
    ds_read_b64_tr_b16 v[152:153], v27 offset:36864
    ds_read_b64_tr_b16 v[154:155], v27 offset:38912
    ds_read_b64_tr_b16 v[156:157], v28 offset:36864
    ds_read_b64_tr_b16 v[158:159], v28 offset:38912
    s_nop 7
    s_nop 3
    v_max3_f32 v32, v80, v81, v82
    v_max3_f32 v33, v83, v84, v85
    v_max3_f32 v34, v86, v87, v88
    v_max3_f32 v35, v89, v90, v91
    v_max3_f32 v36, v92, v93, v94
    v_max3_f32 v32, v32, v33, v34
    v_max3_f32 v35, v35, v36, v95
    v_max_f32 v32, v32, v35
    v_mov_b32 v33, v32
    s_nop 1
    v_permlane32_swap_b32 v32, v33
    v_max_f32 v32, v32, v33
    v_mul_f32 v32, s28, v32
    v_max_f32 v33, v29, v32
    v_sub_f32 v34, v33, v29
    v_cmp_gt_f32 vcc, v34, s32
    s_cmp_lg_u64 vcc, 0
    s_cbranch_scc0 attn_kernel_skip14
    v_sub_f32 v34, v29, v33
    v_exp_f32 v31, v34
    v_mov_b32 v29, v33
    v_mul_f32 v30, v30, v31
    v_mul_f32 v160, v160, v31
    v_mul_f32 v161, v161, v31
    v_mul_f32 v162, v162, v31
    v_mul_f32 v163, v163, v31
    v_mul_f32 v164, v164, v31
    v_mul_f32 v165, v165, v31
    v_mul_f32 v166, v166, v31
    v_mul_f32 v167, v167, v31
    v_mul_f32 v168, v168, v31
    v_mul_f32 v169, v169, v31
    v_mul_f32 v170, v170, v31
    v_mul_f32 v171, v171, v31
    v_mul_f32 v172, v172, v31
    v_mul_f32 v173, v173, v31
    v_mul_f32 v174, v174, v31
    v_mul_f32 v175, v175, v31
    v_mul_f32 v176, v176, v31
    v_mul_f32 v177, v177, v31
    v_mul_f32 v178, v178, v31
    v_mul_f32 v179, v179, v31
    v_mul_f32 v180, v180, v31
    v_mul_f32 v181, v181, v31
    v_mul_f32 v182, v182, v31
    v_mul_f32 v183, v183, v31
    v_mul_f32 v184, v184, v31
    v_mul_f32 v185, v185, v31
    v_mul_f32 v186, v186, v31
    v_mul_f32 v187, v187, v31
    v_mul_f32 v188, v188, v31
    v_mul_f32 v189, v189, v31
    v_mul_f32 v190, v190, v31
    v_mul_f32 v191, v191, v31
    v_mul_f32 v192, v192, v31
    v_mul_f32 v193, v193, v31
    v_mul_f32 v194, v194, v31
    v_mul_f32 v195, v195, v31
    v_mul_f32 v196, v196, v31
    v_mul_f32 v197, v197, v31
    v_mul_f32 v198, v198, v31
    v_mul_f32 v199, v199, v31
    v_mul_f32 v200, v200, v31
    v_mul_f32 v201, v201, v31
    v_mul_f32 v202, v202, v31
    v_mul_f32 v203, v203, v31
    v_mul_f32 v204, v204, v31
    v_mul_f32 v205, v205, v31
    v_mul_f32 v206, v206, v31
    v_mul_f32 v207, v207, v31
    v_mul_f32 v208, v208, v31
    v_mul_f32 v209, v209, v31
    v_mul_f32 v210, v210, v31
    v_mul_f32 v211, v211, v31
    v_mul_f32 v212, v212, v31
    v_mul_f32 v213, v213, v31
    v_mul_f32 v214, v214, v31
    v_mul_f32 v215, v215, v31
    v_mul_f32 v216, v216, v31
    v_mul_f32 v217, v217, v31
    v_mul_f32 v218, v218, v31
    v_mul_f32 v219, v219, v31
    v_mul_f32 v220, v220, v31
    v_mul_f32 v221, v221, v31
    v_mul_f32 v222, v222, v31
    v_mul_f32 v223, v223, v31
attn_kernel_skip14:
    v_fma_f32 v80, v80, s28, -v29
    v_fma_f32 v81, v81, s28, -v29
    v_fma_f32 v82, v82, s28, -v29
    v_fma_f32 v83, v83, s28, -v29
    v_fma_f32 v84, v84, s28, -v29
    v_fma_f32 v85, v85, s28, -v29
    v_fma_f32 v86, v86, s28, -v29
    v_fma_f32 v87, v87, s28, -v29
    v_fma_f32 v88, v88, s28, -v29
    v_fma_f32 v89, v89, s28, -v29
    v_fma_f32 v90, v90, s28, -v29
    v_fma_f32 v91, v91, s28, -v29
    v_fma_f32 v92, v92, s28, -v29
    v_fma_f32 v93, v93, s28, -v29
    v_fma_f32 v94, v94, s28, -v29
    v_fma_f32 v95, v95, s28, -v29
    v_exp_f32 v80, v80
    v_exp_f32 v81, v81
    v_exp_f32 v82, v82
    v_exp_f32 v83, v83
    v_exp_f32 v84, v84
    v_exp_f32 v85, v85
    v_exp_f32 v86, v86
    v_exp_f32 v87, v87
    v_exp_f32 v88, v88
    v_exp_f32 v89, v89
    v_exp_f32 v90, v90
    v_exp_f32 v91, v91
    v_exp_f32 v92, v92
    v_exp_f32 v93, v93
    v_exp_f32 v94, v94
    v_exp_f32 v95, v95
    v_add_f32 v34, v80, v81
    v_add_f32 v30, v30, v34
    v_add_f32 v34, v82, v83
    v_add_f32 v30, v30, v34
    v_add_f32 v34, v84, v85
    v_add_f32 v30, v30, v34
    v_add_f32 v34, v86, v87
    v_add_f32 v30, v30, v34
    v_add_f32 v34, v88, v89
    v_add_f32 v30, v30, v34
    v_add_f32 v34, v90, v91
    v_add_f32 v30, v30, v34
    v_add_f32 v34, v92, v93
    v_add_f32 v30, v30, v34
    v_add_f32 v34, v94, v95
    v_add_f32 v30, v30, v34
    v_cvt_pk_bf16_f32 v40, v80, v81
    v_cvt_pk_bf16_f32 v41, v82, v83
    v_cvt_pk_bf16_f32 v42, v84, v85
    v_cvt_pk_bf16_f32 v43, v86, v87
    v_cvt_pk_bf16_f32 v44, v88, v89
    v_cvt_pk_bf16_f32 v45, v90, v91
    v_cvt_pk_bf16_f32 v46, v92, v93
    v_cvt_pk_bf16_f32 v47, v94, v95
    s_nop 1
    s_waitcnt lgkmcnt(14)
    v_mfma_f32_32x32x16_bf16 v[160:175], v[128:131], v[40:43], v[160:175]
    s_waitcnt lgkmcnt(12)
    v_mfma_f32_32x32x16_bf16 v[176:191], v[132:135], v[40:43], v[176:191]
    s_waitcnt lgkmcnt(10)
    v_mfma_f32_32x32x16_bf16 v[192:207], v[136:139], v[40:43], v[192:207]
    s_waitcnt lgkmcnt(8)
    v_mfma_f32_32x32x16_bf16 v[208:223], v[140:143], v[40:43], v[208:223]
    s_waitcnt lgkmcnt(6)
    v_mfma_f32_32x32x16_bf16 v[160:175], v[144:147], v[44:47], v[160:175]
    s_waitcnt lgkmcnt(4)
    v_mfma_f32_32x32x16_bf16 v[176:191], v[148:151], v[44:47], v[176:191]
    s_waitcnt lgkmcnt(2)
    v_mfma_f32_32x32x16_bf16 v[192:207], v[152:155], v[44:47], v[192:207]
    s_waitcnt lgkmcnt(0)
    v_mfma_f32_32x32x16_bf16 v[208:223], v[156:159], v[44:47], v[208:223]
    s_waitcnt vmcnt(0)
    s_barrier
    ds_read_b128 v[96:99], v5 offset:0
    ds_read_b128 v[100:103], v6 offset:0
    ds_read_b128 v[104:107], v7 offset:0
    ds_read_b128 v[108:111], v8 offset:0
    ds_read_b128 v[112:115], v9 offset:0
    ds_read_b128 v[116:119], v10 offset:0
    ds_read_b128 v[120:123], v11 offset:0
    ds_read_b128 v[124:127], v12 offset:0
    s_waitcnt lgkmcnt(7)
    v_mfma_f32_32x32x16_bf16 v[80:95], v[96:99], v[48:51], 0
    s_waitcnt lgkmcnt(6)
    v_mfma_f32_32x32x16_bf16 v[80:95], v[100:103], v[52:55], v[80:95]
    s_waitcnt lgkmcnt(5)
    v_mfma_f32_32x32x16_bf16 v[80:95], v[104:107], v[56:59], v[80:95]
    s_waitcnt lgkmcnt(4)
    v_mfma_f32_32x32x16_bf16 v[80:95], v[108:111], v[60:63], v[80:95]
    s_waitcnt lgkmcnt(3)
    v_mfma_f32_32x32x16_bf16 v[80:95], v[112:115], v[64:67], v[80:95]
    s_waitcnt lgkmcnt(2)
    v_mfma_f32_32x32x16_bf16 v[80:95], v[116:119], v[68:71], v[80:95]
    s_waitcnt lgkmcnt(1)
    v_mfma_f32_32x32x16_bf16 v[80:95], v[120:123], v[72:75], v[80:95]
    s_waitcnt lgkmcnt(0)
    v_mfma_f32_32x32x16_bf16 v[80:95], v[124:127], v[76:79], v[80:95]
    ds_read_b64_tr_b16 v[128:129], v13 offset:0
    ds_read_b64_tr_b16 v[130:131], v13 offset:2048
    ds_read_b64_tr_b16 v[132:133], v14 offset:0
    ds_read_b64_tr_b16 v[134:135], v14 offset:2048
    ds_read_b64_tr_b16 v[136:137], v15 offset:0
    ds_read_b64_tr_b16 v[138:139], v15 offset:2048
    ds_read_b64_tr_b16 v[140:141], v16 offset:0
    ds_read_b64_tr_b16 v[142:143], v16 offset:2048
    ds_read_b64_tr_b16 v[144:145], v13 offset:4096
    ds_read_b64_tr_b16 v[146:147], v13 offset:6144
    ds_read_b64_tr_b16 v[148:149], v14 offset:4096
    ds_read_b64_tr_b16 v[150:151], v14 offset:6144
    ds_read_b64_tr_b16 v[152:153], v15 offset:4096
    ds_read_b64_tr_b16 v[154:155], v15 offset:6144
    ds_read_b64_tr_b16 v[156:157], v16 offset:4096
    ds_read_b64_tr_b16 v[158:159], v16 offset:6144
    s_nop 7
    s_nop 3
    v_max3_f32 v32, v80, v81, v82
    v_max3_f32 v33, v83, v84, v85
    v_max3_f32 v34, v86, v87, v88
    v_max3_f32 v35, v89, v90, v91
    v_max3_f32 v36, v92, v93, v94
    v_max3_f32 v32, v32, v33, v34
    v_max3_f32 v35, v35, v36, v95
    v_max_f32 v32, v32, v35
    v_mov_b32 v33, v32
    s_nop 1
    v_permlane32_swap_b32 v32, v33
    v_max_f32 v32, v32, v33
    v_mul_f32 v32, s28, v32
    v_max_f32 v33, v29, v32
    v_sub_f32 v34, v33, v29
    v_cmp_gt_f32 vcc, v34, s32
    s_cmp_lg_u64 vcc, 0
    s_cbranch_scc0 attn_kernel_skip15
    v_sub_f32 v34, v29, v33
    v_exp_f32 v31, v34
    v_mov_b32 v29, v33
    v_mul_f32 v30, v30, v31
    v_mul_f32 v160, v160, v31
    v_mul_f32 v161, v161, v31
    v_mul_f32 v162, v162, v31
    v_mul_f32 v163, v163, v31
    v_mul_f32 v164, v164, v31
    v_mul_f32 v165, v165, v31
    v_mul_f32 v166, v166, v31
    v_mul_f32 v167, v167, v31
    v_mul_f32 v168, v168, v31
    v_mul_f32 v169, v169, v31
    v_mul_f32 v170, v170, v31
    v_mul_f32 v171, v171, v31
    v_mul_f32 v172, v172, v31
    v_mul_f32 v173, v173, v31
    v_mul_f32 v174, v174, v31
    v_mul_f32 v175, v175, v31
    v_mul_f32 v176, v176, v31
    v_mul_f32 v177, v177, v31
    v_mul_f32 v178, v178, v31
    v_mul_f32 v179, v179, v31
    v_mul_f32 v180, v180, v31
    v_mul_f32 v181, v181, v31
    v_mul_f32 v182, v182, v31
    v_mul_f32 v183, v183, v31
    v_mul_f32 v184, v184, v31
    v_mul_f32 v185, v185, v31
    v_mul_f32 v186, v186, v31
    v_mul_f32 v187, v187, v31
    v_mul_f32 v188, v188, v31
    v_mul_f32 v189, v189, v31
    v_mul_f32 v190, v190, v31
    v_mul_f32 v191, v191, v31
    v_mul_f32 v192, v192, v31
    v_mul_f32 v193, v193, v31
    v_mul_f32 v194, v194, v31
    v_mul_f32 v195, v195, v31
    v_mul_f32 v196, v196, v31
    v_mul_f32 v197, v197, v31
    v_mul_f32 v198, v198, v31
    v_mul_f32 v199, v199, v31
    v_mul_f32 v200, v200, v31
    v_mul_f32 v201, v201, v31
    v_mul_f32 v202, v202, v31
    v_mul_f32 v203, v203, v31
    v_mul_f32 v204, v204, v31
    v_mul_f32 v205, v205, v31
    v_mul_f32 v206, v206, v31
    v_mul_f32 v207, v207, v31
    v_mul_f32 v208, v208, v31
    v_mul_f32 v209, v209, v31
    v_mul_f32 v210, v210, v31
    v_mul_f32 v211, v211, v31
    v_mul_f32 v212, v212, v31
    v_mul_f32 v213, v213, v31
    v_mul_f32 v214, v214, v31
    v_mul_f32 v215, v215, v31
    v_mul_f32 v216, v216, v31
    v_mul_f32 v217, v217, v31
    v_mul_f32 v218, v218, v31
    v_mul_f32 v219, v219, v31
    v_mul_f32 v220, v220, v31
    v_mul_f32 v221, v221, v31
    v_mul_f32 v222, v222, v31
    v_mul_f32 v223, v223, v31
attn_kernel_skip15:
    v_fma_f32 v80, v80, s28, -v29
    v_fma_f32 v81, v81, s28, -v29
    v_fma_f32 v82, v82, s28, -v29
    v_fma_f32 v83, v83, s28, -v29
    v_fma_f32 v84, v84, s28, -v29
    v_fma_f32 v85, v85, s28, -v29
    v_fma_f32 v86, v86, s28, -v29
    v_fma_f32 v87, v87, s28, -v29
    v_fma_f32 v88, v88, s28, -v29
    v_fma_f32 v89, v89, s28, -v29
    v_fma_f32 v90, v90, s28, -v29
    v_fma_f32 v91, v91, s28, -v29
    v_fma_f32 v92, v92, s28, -v29
    v_fma_f32 v93, v93, s28, -v29
    v_fma_f32 v94, v94, s28, -v29
    v_fma_f32 v95, v95, s28, -v29
    v_exp_f32 v80, v80
    v_exp_f32 v81, v81
    v_exp_f32 v82, v82
    v_exp_f32 v83, v83
    v_exp_f32 v84, v84
    v_exp_f32 v85, v85
    v_exp_f32 v86, v86
    v_exp_f32 v87, v87
    v_exp_f32 v88, v88
    v_exp_f32 v89, v89
    v_exp_f32 v90, v90
    v_exp_f32 v91, v91
    v_exp_f32 v92, v92
    v_exp_f32 v93, v93
    v_exp_f32 v94, v94
    v_exp_f32 v95, v95
    v_add_f32 v34, v80, v81
    v_add_f32 v30, v30, v34
    v_add_f32 v34, v82, v83
    v_add_f32 v30, v30, v34
    v_add_f32 v34, v84, v85
    v_add_f32 v30, v30, v34
    v_add_f32 v34, v86, v87
    v_add_f32 v30, v30, v34
    v_add_f32 v34, v88, v89
    v_add_f32 v30, v30, v34
    v_add_f32 v34, v90, v91
    v_add_f32 v30, v30, v34
    v_add_f32 v34, v92, v93
    v_add_f32 v30, v30, v34
    v_add_f32 v34, v94, v95
    v_add_f32 v30, v30, v34
    v_cvt_pk_bf16_f32 v40, v80, v81
    v_cvt_pk_bf16_f32 v41, v82, v83
    v_cvt_pk_bf16_f32 v42, v84, v85
    v_cvt_pk_bf16_f32 v43, v86, v87
    v_cvt_pk_bf16_f32 v44, v88, v89
    v_cvt_pk_bf16_f32 v45, v90, v91
    v_cvt_pk_bf16_f32 v46, v92, v93
    v_cvt_pk_bf16_f32 v47, v94, v95
    s_nop 1
    s_waitcnt lgkmcnt(14)
    v_mfma_f32_32x32x16_bf16 v[160:175], v[128:131], v[40:43], v[160:175]
    s_waitcnt lgkmcnt(12)
    v_mfma_f32_32x32x16_bf16 v[176:191], v[132:135], v[40:43], v[176:191]
    s_waitcnt lgkmcnt(10)
    v_mfma_f32_32x32x16_bf16 v[192:207], v[136:139], v[40:43], v[192:207]
    s_waitcnt lgkmcnt(8)
    v_mfma_f32_32x32x16_bf16 v[208:223], v[140:143], v[40:43], v[208:223]
    s_waitcnt lgkmcnt(6)
    v_mfma_f32_32x32x16_bf16 v[160:175], v[144:147], v[44:47], v[160:175]
    s_waitcnt lgkmcnt(4)
    v_mfma_f32_32x32x16_bf16 v[176:191], v[148:151], v[44:47], v[176:191]
    s_waitcnt lgkmcnt(2)
    v_mfma_f32_32x32x16_bf16 v[192:207], v[152:155], v[44:47], v[192:207]
    s_waitcnt lgkmcnt(0)
    v_mfma_f32_32x32x16_bf16 v[208:223], v[156:159], v[44:47], v[208:223]
    s_nop 7
    s_nop 7
    v_mov_b32 v32, v30
    s_nop 1
    v_permlane32_swap_b32 v30, v32
    v_add_f32 v30, v30, v32
    s_barrier
    v_lshlrev_b32 v32, 4, v1
    s_lshl_b32 s25, s22, 14
    v_add_u32 v32, s25, v32
    v_lshlrev_b32 v38, 2, v1
    s_lshl_b32 s26, s22, 10
    s_add_u32 s26, s26, 65536
    v_add_u32 v38, s26, v38
    s_cmp_eq_u32 s23, 0
    s_cbranch_scc1 attn_kernel_g0
    ds_write_b128 v32, v[160:163] offset:8192
    ds_write_b128 v32, v[164:167] offset:9216
    ds_write_b128 v32, v[168:171] offset:10240
    ds_write_b128 v32, v[172:175] offset:11264
    ds_write_b128 v32, v[176:179] offset:12288
    ds_write_b128 v32, v[180:183] offset:13312
    ds_write_b128 v32, v[184:187] offset:14336
    ds_write_b128 v32, v[188:191] offset:15360
    ds_write_b32 v38, v29 offset:512
    ds_write_b32 v38, v30 offset:768
    s_waitcnt lgkmcnt(0)
    s_barrier
    ds_read_b32 v33, v38 offset:0
    ds_read_b32 v34, v38 offset:256
    ds_read_b128 v[96:99], v32 offset:0
    ds_read_b128 v[100:103], v32 offset:1024
    ds_read_b128 v[104:107], v32 offset:2048
    ds_read_b128 v[108:111], v32 offset:3072
    ds_read_b128 v[112:115], v32 offset:4096
    ds_read_b128 v[116:119], v32 offset:5120
    ds_read_b128 v[120:123], v32 offset:6144
    ds_read_b128 v[124:127], v32 offset:7168
    s_waitcnt lgkmcnt(8)
    v_max_f32 v35, v29, v33
    v_sub_f32 v36, v29, v35
    v_sub_f32 v37, v33, v35
    v_exp_f32 v36, v36
    v_exp_f32 v37, v37
    s_nop 0
    v_mul_f32 v30, v30, v36
    v_fma_f32 v30, v34, v37, v30
    v_rcp_f32 v30, v30
    s_nop 0
    v_mul_f32 v36, v36, v30
    v_mul_f32 v37, v37, v30
    s_lshl_b32 s25, s21, 12
    s_add_u32 s25, s25, 98304
    v_and_b32 v86, 31, v1
    v_lshlrev_b32 v86, 7, v86
    v_add_u32 v86, s25, v86
    v_lshrrev_b32 v87, 5, v1
    v_lshl_add_u32 v80, v87, 3, v86
    v_and_b32 v81, 7, v1
    s_waitcnt lgkmcnt(7)
    v_mul_f32 v192, v192, v36
    v_fma_f32 v192, v96, v37, v192
    v_mul_f32 v193, v193, v36
    v_fma_f32 v193, v97, v37, v193
    v_mul_f32 v194, v194, v36
    v_fma_f32 v194, v98, v37, v194
    v_mul_f32 v195, v195, v36
    v_fma_f32 v195, v99, v37, v195
    v_cvt_pk_bf16_f32 v128, v192, v193
    v_cvt_pk_bf16_f32 v129, v194, v195
    v_xor_b32 v82, 0, v81
    v_lshl_add_u32 v82, v82, 4, v80
    ds_write_b64 v82, v[128:129]
    s_waitcnt lgkmcnt(6)
    v_mul_f32 v196, v196, v36
    v_fma_f32 v196, v100, v37, v196
    v_mul_f32 v197, v197, v36
    v_fma_f32 v197, v101, v37, v197
    v_mul_f32 v198, v198, v36
    v_fma_f32 v198, v102, v37, v198
    v_mul_f32 v199, v199, v36
    v_fma_f32 v199, v103, v37, v199
    v_cvt_pk_bf16_f32 v130, v196, v197
    v_cvt_pk_bf16_f32 v131, v198, v199
    v_xor_b32 v82, 1, v81
    v_lshl_add_u32 v82, v82, 4, v80
    ds_write_b64 v82, v[130:131]
    s_waitcnt lgkmcnt(5)
    v_mul_f32 v200, v200, v36
    v_fma_f32 v200, v104, v37, v200
    v_mul_f32 v201, v201, v36
    v_fma_f32 v201, v105, v37, v201
    v_mul_f32 v202, v202, v36
    v_fma_f32 v202, v106, v37, v202
    v_mul_f32 v203, v203, v36
    v_fma_f32 v203, v107, v37, v203
    v_cvt_pk_bf16_f32 v132, v200, v201
    v_cvt_pk_bf16_f32 v133, v202, v203
    v_xor_b32 v82, 2, v81
    v_lshl_add_u32 v82, v82, 4, v80
    ds_write_b64 v82, v[132:133]
    s_waitcnt lgkmcnt(4)
    v_mul_f32 v204, v204, v36
    v_fma_f32 v204, v108, v37, v204
    v_mul_f32 v205, v205, v36
    v_fma_f32 v205, v109, v37, v205
    v_mul_f32 v206, v206, v36
    v_fma_f32 v206, v110, v37, v206
    v_mul_f32 v207, v207, v36
    v_fma_f32 v207, v111, v37, v207
    v_cvt_pk_bf16_f32 v134, v204, v205
    v_cvt_pk_bf16_f32 v135, v206, v207
    v_xor_b32 v82, 3, v81
    v_lshl_add_u32 v82, v82, 4, v80
    ds_write_b64 v82, v[134:135]
    s_waitcnt lgkmcnt(3)
    v_mul_f32 v208, v208, v36
    v_fma_f32 v208, v112, v37, v208
    v_mul_f32 v209, v209, v36
    v_fma_f32 v209, v113, v37, v209
    v_mul_f32 v210, v210, v36
    v_fma_f32 v210, v114, v37, v210
    v_mul_f32 v211, v211, v36
    v_fma_f32 v211, v115, v37, v211
    v_cvt_pk_bf16_f32 v136, v208, v209
    v_cvt_pk_bf16_f32 v137, v210, v211
    v_xor_b32 v82, 4, v81
    v_lshl_add_u32 v82, v82, 4, v80
    ds_write_b64 v82, v[136:137]
    s_waitcnt lgkmcnt(2)
    v_mul_f32 v212, v212, v36
    v_fma_f32 v212, v116, v37, v212
    v_mul_f32 v213, v213, v36
    v_fma_f32 v213, v117, v37, v213
    v_mul_f32 v214, v214, v36
    v_fma_f32 v214, v118, v37, v214
    v_mul_f32 v215, v215, v36
    v_fma_f32 v215, v119, v37, v215
    v_cvt_pk_bf16_f32 v138, v212, v213
    v_cvt_pk_bf16_f32 v139, v214, v215
    v_xor_b32 v82, 5, v81
    v_lshl_add_u32 v82, v82, 4, v80
    ds_write_b64 v82, v[138:139]
    s_waitcnt lgkmcnt(1)
    v_mul_f32 v216, v216, v36
    v_fma_f32 v216, v120, v37, v216
    v_mul_f32 v217, v217, v36
    v_fma_f32 v217, v121, v37, v217
    v_mul_f32 v218, v218, v36
    v_fma_f32 v218, v122, v37, v218
    v_mul_f32 v219, v219, v36
    v_fma_f32 v219, v123, v37, v219
    v_cvt_pk_bf16_f32 v140, v216, v217
    v_cvt_pk_bf16_f32 v141, v218, v219
    v_xor_b32 v82, 6, v81
    v_lshl_add_u32 v82, v82, 4, v80
    ds_write_b64 v82, v[140:141]
    s_waitcnt lgkmcnt(0)
    v_mul_f32 v220, v220, v36
    v_fma_f32 v220, v124, v37, v220
    v_mul_f32 v221, v221, v36
    v_fma_f32 v221, v125, v37, v221
    v_mul_f32 v222, v222, v36
    v_fma_f32 v222, v126, v37, v222
    v_mul_f32 v223, v223, v36
    v_fma_f32 v223, v127, v37, v223
    v_cvt_pk_bf16_f32 v142, v220, v221
    v_cvt_pk_bf16_f32 v143, v222, v223
    v_xor_b32 v82, 7, v81
    v_lshl_add_u32 v82, v82, 4, v80
    ds_write_b64 v82, v[142:143]
    s_waitcnt lgkmcnt(0)
    v_lshrrev_b32 v83, 3, v1
    v_xor_b32 v87, v83, v1
    v_and_b32 v87, 7, v87
    v_lshlrev_b32 v87, 4, v87
    v_lshl_add_u32 v87, v83, 7, v87
    v_add_u32 v87, s25, v87
    ds_read_b128 v[96:99], v87 offset:0
    ds_read_b128 v[100:103], v87 offset:1024
    ds_read_b128 v[104:107], v87 offset:2048
    ds_read_b128 v[108:111], v87 offset:3072
    s_lshr_b32 s26, s2, 5
    s_lshl_b32 s26, s26, 7
    s_lshl_b32 s27, s22, 5
    s_add_u32 s26, s26, s27
    s_mul_i32 s26, s26, 8320
    s_and_b32 s27, s2, 31
    s_lshl_b32 s27, s27, 8
    s_add_u32 s31, s26, s27
    s_add_u32 s31, s31, 128
    v_mul_u32_u24 v85, 8320, v83
    v_and_b32 v84, 7, v1
    v_lshl_add_u32 v85, v84, 4, v85
    s_waitcnt lgkmcnt(3)
    s_add_u32 s26, s31, 0
    buffer_store_dwordx4 v[96:99], v85, s[36:39], s26 offen
    s_waitcnt lgkmcnt(2)
    s_add_u32 s26, s31, 66560
    buffer_store_dwordx4 v[100:103], v85, s[36:39], s26 offen
    s_waitcnt lgkmcnt(1)
    s_add_u32 s26, s31, 133120
    buffer_store_dwordx4 v[104:107], v85, s[36:39], s26 offen
    s_waitcnt lgkmcnt(0)
    s_add_u32 s26, s31, 199680
    buffer_store_dwordx4 v[108:111], v85, s[36:39], s26 offen
    s_branch attn_kernel_fin
attn_kernel_g0:
    ds_write_b128 v32, v[192:195] offset:0
    ds_write_b128 v32, v[196:199] offset:1024
    ds_write_b128 v32, v[200:203] offset:2048
    ds_write_b128 v32, v[204:207] offset:3072
    ds_write_b128 v32, v[208:211] offset:4096
    ds_write_b128 v32, v[212:215] offset:5120
    ds_write_b128 v32, v[216:219] offset:6144
    ds_write_b128 v32, v[220:223] offset:7168
    ds_write_b32 v38, v29 offset:0
    ds_write_b32 v38, v30 offset:256
    s_waitcnt lgkmcnt(0)
    s_barrier
    ds_read_b32 v33, v38 offset:512
    ds_read_b32 v34, v38 offset:768
    ds_read_b128 v[96:99], v32 offset:8192
    ds_read_b128 v[100:103], v32 offset:9216
    ds_read_b128 v[104:107], v32 offset:10240
    ds_read_b128 v[108:111], v32 offset:11264
    ds_read_b128 v[112:115], v32 offset:12288
    ds_read_b128 v[116:119], v32 offset:13312
    ds_read_b128 v[120:123], v32 offset:14336
    ds_read_b128 v[124:127], v32 offset:15360
    s_waitcnt lgkmcnt(8)
    v_max_f32 v35, v29, v33
    v_sub_f32 v36, v29, v35
    v_sub_f32 v37, v33, v35
    v_exp_f32 v36, v36
    v_exp_f32 v37, v37
    s_nop 0
    v_mul_f32 v30, v30, v36
    v_fma_f32 v30, v34, v37, v30
    v_rcp_f32 v30, v30
    s_nop 0
    v_mul_f32 v36, v36, v30
    v_mul_f32 v37, v37, v30
    s_lshl_b32 s25, s21, 12
    s_add_u32 s25, s25, 98304
    v_and_b32 v86, 31, v1
    v_lshlrev_b32 v86, 7, v86
    v_add_u32 v86, s25, v86
    v_lshrrev_b32 v87, 5, v1
    v_lshl_add_u32 v80, v87, 3, v86
    v_and_b32 v81, 7, v1
    s_waitcnt lgkmcnt(7)
    v_mul_f32 v160, v160, v36
    v_fma_f32 v160, v96, v37, v160
    v_mul_f32 v161, v161, v36
    v_fma_f32 v161, v97, v37, v161
    v_mul_f32 v162, v162, v36
    v_fma_f32 v162, v98, v37, v162
    v_mul_f32 v163, v163, v36
    v_fma_f32 v163, v99, v37, v163
    v_cvt_pk_bf16_f32 v128, v160, v161
    v_cvt_pk_bf16_f32 v129, v162, v163
    v_xor_b32 v82, 0, v81
    v_lshl_add_u32 v82, v82, 4, v80
    ds_write_b64 v82, v[128:129]
    s_waitcnt lgkmcnt(6)
    v_mul_f32 v164, v164, v36
    v_fma_f32 v164, v100, v37, v164
    v_mul_f32 v165, v165, v36
    v_fma_f32 v165, v101, v37, v165
    v_mul_f32 v166, v166, v36
    v_fma_f32 v166, v102, v37, v166
    v_mul_f32 v167, v167, v36
    v_fma_f32 v167, v103, v37, v167
    v_cvt_pk_bf16_f32 v130, v164, v165
    v_cvt_pk_bf16_f32 v131, v166, v167
    v_xor_b32 v82, 1, v81
    v_lshl_add_u32 v82, v82, 4, v80
    ds_write_b64 v82, v[130:131]
    s_waitcnt lgkmcnt(5)
    v_mul_f32 v168, v168, v36
    v_fma_f32 v168, v104, v37, v168
    v_mul_f32 v169, v169, v36
    v_fma_f32 v169, v105, v37, v169
    v_mul_f32 v170, v170, v36
    v_fma_f32 v170, v106, v37, v170
    v_mul_f32 v171, v171, v36
    v_fma_f32 v171, v107, v37, v171
    v_cvt_pk_bf16_f32 v132, v168, v169
    v_cvt_pk_bf16_f32 v133, v170, v171
    v_xor_b32 v82, 2, v81
    v_lshl_add_u32 v82, v82, 4, v80
    ds_write_b64 v82, v[132:133]
    s_waitcnt lgkmcnt(4)
    v_mul_f32 v172, v172, v36
    v_fma_f32 v172, v108, v37, v172
    v_mul_f32 v173, v173, v36
    v_fma_f32 v173, v109, v37, v173
    v_mul_f32 v174, v174, v36
    v_fma_f32 v174, v110, v37, v174
    v_mul_f32 v175, v175, v36
    v_fma_f32 v175, v111, v37, v175
    v_cvt_pk_bf16_f32 v134, v172, v173
    v_cvt_pk_bf16_f32 v135, v174, v175
    v_xor_b32 v82, 3, v81
    v_lshl_add_u32 v82, v82, 4, v80
    ds_write_b64 v82, v[134:135]
    s_waitcnt lgkmcnt(3)
    v_mul_f32 v176, v176, v36
    v_fma_f32 v176, v112, v37, v176
    v_mul_f32 v177, v177, v36
    v_fma_f32 v177, v113, v37, v177
    v_mul_f32 v178, v178, v36
    v_fma_f32 v178, v114, v37, v178
    v_mul_f32 v179, v179, v36
    v_fma_f32 v179, v115, v37, v179
    v_cvt_pk_bf16_f32 v136, v176, v177
    v_cvt_pk_bf16_f32 v137, v178, v179
    v_xor_b32 v82, 4, v81
    v_lshl_add_u32 v82, v82, 4, v80
    ds_write_b64 v82, v[136:137]
    s_waitcnt lgkmcnt(2)
    v_mul_f32 v180, v180, v36
    v_fma_f32 v180, v116, v37, v180
    v_mul_f32 v181, v181, v36
    v_fma_f32 v181, v117, v37, v181
    v_mul_f32 v182, v182, v36
    v_fma_f32 v182, v118, v37, v182
    v_mul_f32 v183, v183, v36
    v_fma_f32 v183, v119, v37, v183
    v_cvt_pk_bf16_f32 v138, v180, v181
    v_cvt_pk_bf16_f32 v139, v182, v183
    v_xor_b32 v82, 5, v81
    v_lshl_add_u32 v82, v82, 4, v80
    ds_write_b64 v82, v[138:139]
    s_waitcnt lgkmcnt(1)
    v_mul_f32 v184, v184, v36
    v_fma_f32 v184, v120, v37, v184
    v_mul_f32 v185, v185, v36
    v_fma_f32 v185, v121, v37, v185
    v_mul_f32 v186, v186, v36
    v_fma_f32 v186, v122, v37, v186
    v_mul_f32 v187, v187, v36
    v_fma_f32 v187, v123, v37, v187
    v_cvt_pk_bf16_f32 v140, v184, v185
    v_cvt_pk_bf16_f32 v141, v186, v187
    v_xor_b32 v82, 6, v81
    v_lshl_add_u32 v82, v82, 4, v80
    ds_write_b64 v82, v[140:141]
    s_waitcnt lgkmcnt(0)
    v_mul_f32 v188, v188, v36
    v_fma_f32 v188, v124, v37, v188
    v_mul_f32 v189, v189, v36
    v_fma_f32 v189, v125, v37, v189
    v_mul_f32 v190, v190, v36
    v_fma_f32 v190, v126, v37, v190
    v_mul_f32 v191, v191, v36
    v_fma_f32 v191, v127, v37, v191
    v_cvt_pk_bf16_f32 v142, v188, v189
    v_cvt_pk_bf16_f32 v143, v190, v191
    v_xor_b32 v82, 7, v81
    v_lshl_add_u32 v82, v82, 4, v80
    ds_write_b64 v82, v[142:143]
    s_waitcnt lgkmcnt(0)
    v_lshrrev_b32 v83, 3, v1
    v_xor_b32 v87, v83, v1
    v_and_b32 v87, 7, v87
    v_lshlrev_b32 v87, 4, v87
    v_lshl_add_u32 v87, v83, 7, v87
    v_add_u32 v87, s25, v87
    ds_read_b128 v[96:99], v87 offset:0
    ds_read_b128 v[100:103], v87 offset:1024
    ds_read_b128 v[104:107], v87 offset:2048
    ds_read_b128 v[108:111], v87 offset:3072
    s_lshr_b32 s26, s2, 5
    s_lshl_b32 s26, s26, 7
    s_lshl_b32 s27, s22, 5
    s_add_u32 s26, s26, s27
    s_mul_i32 s26, s26, 8320
    s_and_b32 s27, s2, 31
    s_lshl_b32 s27, s27, 8
    s_add_u32 s31, s26, s27
    s_add_u32 s31, s31, 0
    v_mul_u32_u24 v85, 8320, v83
    v_and_b32 v84, 7, v1
    v_lshl_add_u32 v85, v84, 4, v85
    s_waitcnt lgkmcnt(3)
    s_add_u32 s26, s31, 0
    buffer_store_dwordx4 v[96:99], v85, s[36:39], s26 offen
    s_waitcnt lgkmcnt(2)
    s_add_u32 s26, s31, 66560
    buffer_store_dwordx4 v[100:103], v85, s[36:39], s26 offen
    s_waitcnt lgkmcnt(1)
    s_add_u32 s26, s31, 133120
    buffer_store_dwordx4 v[104:107], v85, s[36:39], s26 offen
    s_waitcnt lgkmcnt(0)
    s_add_u32 s26, s31, 199680
    buffer_store_dwordx4 v[108:111], v85, s[36:39], s26 offen
attn_kernel_fin:
attn_kernel_done:
    s_endpgm
.text
.globl oproj_kernel
.p2align 8
.type oproj_kernel,@function
oproj_kernel:
    s_cmp_ge_u32 s2, 144
    s_cbranch_scc1 oproj_kernel_done
    s_load_dwordx2 s[4:5], s[0:1], 56
    s_load_dwordx2 s[8:9], s[0:1], 32
    s_load_dwordx2 s[12:13], s[0:1], 40
    s_and_b32 s16, s2, 15
    s_lshr_b32 s17, s2, 4
    s_mul_i32 s16, s16, 64
    s_mul_i32 s17, s17, 64
    v_lshrrev_b32 v6, 6, v0
    v_and_b32 v1, 63, v0
    s_nop 0
    v_readfirstlane_b32 s18, v6
    s_waitcnt lgkmcnt(0)
    s_add_u32 s4, s4, 8388608
    s_addc_u32 s5, s5, 0
    s_and_b32 s5, s5, 0xffff
    s_mov_b32 s6, 8519680
    s_mov_b32 s7, 0x00020000
    s_and_b32 s9, s9, 0xffff
    s_mov_b32 s10, 4718592
    s_mov_b32 s11, 0x00020000
    s_and_b32 s13, s13, 0xffff
    s_mov_b32 s14, 1179648
    s_mov_b32 s15, 0x00020000
    v_lshrrev_b32 v6, 3, v1
    s_mov_b32 s22, 8320
    v_mul_lo_u32 v2, v6, s22
    v_and_b32 v6, 7, v1
    v_lshrrev_b32 v7, 4, v1
    v_xor_b32 v6, v6, v7
    v_lshlrev_b32 v7, 4, v6
    v_add_u32 v3, v2, v7
    v_xor_b32 v7, 64, v7
    v_add_u32 v8, v2, v7
    v_mov_b32 v2, v3
    v_mov_b32 v3, v8
    v_lshrrev_b32 v6, 3, v1
    v_lshrrev_b32 v7, 4, v1
    v_and_b32 v7, 1, v7
    v_lshlrev_b32 v7, 2, v7
    v_and_b32 v8, 7, v1
    v_xor_b32 v7, v7, v8
    s_mov_b32 s22, 1152
    v_mul_lo_u32 v4, v6, s22
    v_lshlrev_b32 v7, 4, v7
    v_add_u32 v4, v4, v7
    s_mul_i32 s22, s18, 16
    s_add_u32 s22, s22, s16
    s_mul_i32 s20, s22, 8320
    s_mul_i32 s21, s18, 18432
    s_lshl_b32 s22, s17, 1
    s_add_u32 s21, s21, s22
    s_mul_i32 s26, s18, 2048
    s_mul_i32 s27, s18, 2048
    s_add_u32 s27, s27, 8192
    s_lshr_b32 s22, s18, 1
    s_and_b32 s23, s18, 1
    s_mul_i32 s22, s22, 32
    s_mul_i32 s23, s23, 32
    v_and_b32 v6, 31, v1
    v_add_u32 v6, s22, v6
    v_lshlrev_b32 v6, 7, v6
    v_lshrrev_b32 v7, 5, v1
    v_lshrrev_b32 v8, 1, v1
    v_and_b32 v8, 7, v8
    v_xor_b32 v7, v7, v8
    v_xor_b32 v8, 0, v7
    v_lshl_add_u32 v10, v8, 4, v6
    v_xor_b32 v8, 2, v7
    v_lshl_add_u32 v11, v8, 4, v6
    v_xor_b32 v8, 4, v7
    v_lshl_add_u32 v12, v8, 4, v6
    v_xor_b32 v8, 6, v7
    v_lshl_add_u32 v13, v8, 4, v6
    v_lshrrev_b32 v6, 5, v1
    v_lshlrev_b32 v6, 3, v6
    v_lshrrev_b32 v7, 2, v1
    v_and_b32 v7, 3, v7
    v_add_u32 v6, v6, v7
    v_mul_u32_u24 v6, 128, v6
    v_add_u32 v6, 8192, v6
    v_and_b32 v8, 1, v1
    v_lshl_add_u32 v6, v8, 3, v6
    v_lshrrev_b32 v7, 1, v7
    v_lshlrev_b32 v7, 2, v7
    v_lshrrev_b32 v8, 4, v1
    v_and_b32 v8, 1, v8
    v_lshlrev_b32 v8, 1, v8
    v_lshrrev_b32 v9, 1, v1
    v_and_b32 v9, 1, v9
    v_add_u32 v8, v8, v9
    s_lshr_b32 s23, s23, 3
    v_add_u32 v8, s23, v8
    v_add_u32 v9, 0, v8
    v_xor_b32 v9, v9, v7
    v_lshl_add_u32 v14, v9, 4, v6
    v_mov_b32 v36, 0
    v_mov_b32 v37, 0
    v_mov_b32 v38, 0
    v_mov_b32 v39, 0
    v_mov_b32 v40, 0
    v_mov_b32 v41, 0
    v_mov_b32 v42, 0
    v_mov_b32 v43, 0
    v_mov_b32 v44, 0
    v_mov_b32 v45, 0
    v_mov_b32 v46, 0
    v_mov_b32 v47, 0
    v_mov_b32 v48, 0
    v_mov_b32 v49, 0
    v_mov_b32 v50, 0
    v_mov_b32 v51, 0
    s_add_u32 s22, s26, 0
    s_mov_b32 m0, s22
    s_add_u32 s23, s20, 0
    buffer_load_dwordx4 v2, s[4:7], s23 offen lds
    s_add_u32 s22, s26, 1024
    s_mov_b32 m0, s22
    s_add_u32 s23, s20, 66560
    buffer_load_dwordx4 v3, s[4:7], s23 offen lds
    s_add_u32 s22, s27, 0
    s_mov_b32 m0, s22
    s_add_u32 s23, s21, 0
    buffer_load_dwordx4 v4, s[8:11], s23 offen lds
    s_add_u32 s22, s27, 1024
    s_mov_b32 m0, s22
    s_add_u32 s23, s21, 9216
    buffer_load_dwordx4 v4, s[8:11], s23 offen lds
    s_add_u32 s20, s20, 128
    s_add_u32 s21, s21, 73728
    s_add_u32 s22, s26, 16384
    s_mov_b32 m0, s22
    s_add_u32 s23, s20, 0
    buffer_load_dwordx4 v2, s[4:7], s23 offen lds
    s_add_u32 s22, s26, 17408
    s_mov_b32 m0, s22
    s_add_u32 s23, s20, 66560
    buffer_load_dwordx4 v3, s[4:7], s23 offen lds
    s_add_u32 s22, s27, 16384
    s_mov_b32 m0, s22
    s_add_u32 s23, s21, 0
    buffer_load_dwordx4 v4, s[8:11], s23 offen lds
    s_add_u32 s22, s27, 17408
    s_mov_b32 m0, s22
    s_add_u32 s23, s21, 9216
    buffer_load_dwordx4 v4, s[8:11], s23 offen lds
    s_add_u32 s20, s20, 128
    s_add_u32 s21, s21, 73728
    s_add_u32 s22, s26, 32768
    s_mov_b32 m0, s22
    s_add_u32 s23, s20, 0
    buffer_load_dwordx4 v2, s[4:7], s23 offen lds
    s_add_u32 s22, s26, 33792
    s_mov_b32 m0, s22
    s_add_u32 s23, s20, 66560
    buffer_load_dwordx4 v3, s[4:7], s23 offen lds
    s_add_u32 s22, s27, 32768
    s_mov_b32 m0, s22
    s_add_u32 s23, s21, 0
    buffer_load_dwordx4 v4, s[8:11], s23 offen lds
    s_add_u32 s22, s27, 33792
    s_mov_b32 m0, s22
    s_add_u32 s23, s21, 9216
    buffer_load_dwordx4 v4, s[8:11], s23 offen lds
    s_add_u32 s20, s20, 128
    s_add_u32 s21, s21, 73728
    s_add_u32 s22, s26, 49152
    s_mov_b32 m0, s22
    s_add_u32 s23, s20, 0
    buffer_load_dwordx4 v2, s[4:7], s23 offen lds
    s_add_u32 s22, s26, 50176
    s_mov_b32 m0, s22
    s_add_u32 s23, s20, 66560
    buffer_load_dwordx4 v3, s[4:7], s23 offen lds
    s_add_u32 s22, s27, 49152
    s_mov_b32 m0, s22
    s_add_u32 s23, s21, 0
    buffer_load_dwordx4 v4, s[8:11], s23 offen lds
    s_add_u32 s22, s27, 50176
    s_mov_b32 m0, s22
    s_add_u32 s23, s21, 9216
    buffer_load_dwordx4 v4, s[8:11], s23 offen lds
    s_add_u32 s20, s20, 128
    s_add_u32 s21, s21, 73728
    s_add_u32 s22, s26, 65536
    s_mov_b32 m0, s22
    s_add_u32 s23, s20, 0
    buffer_load_dwordx4 v2, s[4:7], s23 offen lds
    s_add_u32 s22, s26, 66560
    s_mov_b32 m0, s22
    s_add_u32 s23, s20, 66560
    buffer_load_dwordx4 v3, s[4:7], s23 offen lds
    s_add_u32 s22, s27, 65536
    s_mov_b32 m0, s22
    s_add_u32 s23, s21, 0
    buffer_load_dwordx4 v4, s[8:11], s23 offen lds
    s_add_u32 s22, s27, 66560
    s_mov_b32 m0, s22
    s_add_u32 s23, s21, 9216
    buffer_load_dwordx4 v4, s[8:11], s23 offen lds
    s_add_u32 s20, s20, 128
    s_add_u32 s21, s21, 73728
    s_waitcnt vmcnt(16)
    s_barrier
    v_add_u32 v15, 0, v10
    v_add_u32 v16, 0, v11
    v_add_u32 v17, 0, v12
    v_add_u32 v18, 0, v13
    v_add_u32 v19, 0, v14
    ds_read_b128 v[20:23], v15 offset:0
    ds_read_b64_tr_b16 v[28:29], v19 offset:0
    ds_read_b64_tr_b16 v[30:31], v19 offset:512
    s_mov_b32 s25, 9
oproj_kernel_loop:
    s_waitcnt vmcnt(12)
    s_barrier
    s_add_u32 s22, s26, 81920
    s_mov_b32 m0, s22
    s_add_u32 s23, s20, 0
    buffer_load_dwordx4 v2, s[4:7], s23 offen lds
    s_add_u32 s22, s26, 82944
    s_mov_b32 m0, s22
    s_add_u32 s23, s20, 66560
    buffer_load_dwordx4 v3, s[4:7], s23 offen lds
    s_add_u32 s22, s27, 81920
    s_mov_b32 m0, s22
    s_add_u32 s23, s21, 0
    buffer_load_dwordx4 v4, s[8:11], s23 offen lds
    s_add_u32 s22, s27, 82944
    s_mov_b32 m0, s22
    s_add_u32 s23, s21, 9216
    buffer_load_dwordx4 v4, s[8:11], s23 offen lds
    s_add_u32 s20, s20, 128
    s_add_u32 s21, s21, 73728
    ds_read_b128 v[24:27], v16 offset:0
    ds_read_b64_tr_b16 v[32:33], v19 offset:2048
    ds_read_b64_tr_b16 v[34:35], v19 offset:2560
    s_waitcnt lgkmcnt(3)
    v_mfma_f32_32x32x16_bf16 v[36:51], v[28:31], v[20:23], v[36:51]
    ds_read_b128 v[20:23], v17 offset:0
    ds_read_b64_tr_b16 v[28:29], v19 offset:4096
    ds_read_b64_tr_b16 v[30:31], v19 offset:4608
    s_waitcnt lgkmcnt(3)
    v_mfma_f32_32x32x16_bf16 v[36:51], v[32:35], v[24:27], v[36:51]
    ds_read_b128 v[24:27], v18 offset:0
    ds_read_b64_tr_b16 v[32:33], v19 offset:6144
    ds_read_b64_tr_b16 v[34:35], v19 offset:6656
    s_waitcnt lgkmcnt(3)
    v_mfma_f32_32x32x16_bf16 v[36:51], v[28:31], v[20:23], v[36:51]
    v_add_u32 v15, 16384, v10
    v_add_u32 v16, 16384, v11
    v_add_u32 v17, 16384, v12
    v_add_u32 v18, 16384, v13
    v_add_u32 v19, 16384, v14
    ds_read_b128 v[20:23], v15 offset:0
    ds_read_b64_tr_b16 v[28:29], v19 offset:0
    ds_read_b64_tr_b16 v[30:31], v19 offset:512
    s_waitcnt lgkmcnt(3)
    v_mfma_f32_32x32x16_bf16 v[36:51], v[32:35], v[24:27], v[36:51]
    s_waitcnt vmcnt(12)
    s_barrier
    s_add_u32 s22, s26, 0
    s_mov_b32 m0, s22
    s_add_u32 s23, s20, 0
    buffer_load_dwordx4 v2, s[4:7], s23 offen lds
    s_add_u32 s22, s26, 1024
    s_mov_b32 m0, s22
    s_add_u32 s23, s20, 66560
    buffer_load_dwordx4 v3, s[4:7], s23 offen lds
    s_add_u32 s22, s27, 0
    s_mov_b32 m0, s22
    s_add_u32 s23, s21, 0
    buffer_load_dwordx4 v4, s[8:11], s23 offen lds
    s_add_u32 s22, s27, 1024
    s_mov_b32 m0, s22
    s_add_u32 s23, s21, 9216
    buffer_load_dwordx4 v4, s[8:11], s23 offen lds
    s_add_u32 s20, s20, 128
    s_add_u32 s21, s21, 73728
    ds_read_b128 v[24:27], v16 offset:0
    ds_read_b64_tr_b16 v[32:33], v19 offset:2048
    ds_read_b64_tr_b16 v[34:35], v19 offset:2560
    s_waitcnt lgkmcnt(3)
    v_mfma_f32_32x32x16_bf16 v[36:51], v[28:31], v[20:23], v[36:51]
    ds_read_b128 v[20:23], v17 offset:0
    ds_read_b64_tr_b16 v[28:29], v19 offset:4096
    ds_read_b64_tr_b16 v[30:31], v19 offset:4608
    s_waitcnt lgkmcnt(3)
    v_mfma_f32_32x32x16_bf16 v[36:51], v[32:35], v[24:27], v[36:51]
    ds_read_b128 v[24:27], v18 offset:0
    ds_read_b64_tr_b16 v[32:33], v19 offset:6144
    ds_read_b64_tr_b16 v[34:35], v19 offset:6656
    s_waitcnt lgkmcnt(3)
    v_mfma_f32_32x32x16_bf16 v[36:51], v[28:31], v[20:23], v[36:51]
    v_add_u32 v15, 32768, v10
    v_add_u32 v16, 32768, v11
    v_add_u32 v17, 32768, v12
    v_add_u32 v18, 32768, v13
    v_add_u32 v19, 32768, v14
    ds_read_b128 v[20:23], v15 offset:0
    ds_read_b64_tr_b16 v[28:29], v19 offset:0
    ds_read_b64_tr_b16 v[30:31], v19 offset:512
    s_waitcnt lgkmcnt(3)
    v_mfma_f32_32x32x16_bf16 v[36:51], v[32:35], v[24:27], v[36:51]
    s_waitcnt vmcnt(12)
    s_barrier
    s_add_u32 s22, s26, 16384
    s_mov_b32 m0, s22
    s_add_u32 s23, s20, 0
    buffer_load_dwordx4 v2, s[4:7], s23 offen lds
    s_add_u32 s22, s26, 17408
    s_mov_b32 m0, s22
    s_add_u32 s23, s20, 66560
    buffer_load_dwordx4 v3, s[4:7], s23 offen lds
    s_add_u32 s22, s27, 16384
    s_mov_b32 m0, s22
    s_add_u32 s23, s21, 0
    buffer_load_dwordx4 v4, s[8:11], s23 offen lds
    s_add_u32 s22, s27, 17408
    s_mov_b32 m0, s22
    s_add_u32 s23, s21, 9216
    buffer_load_dwordx4 v4, s[8:11], s23 offen lds
    s_add_u32 s20, s20, 128
    s_add_u32 s21, s21, 73728
    ds_read_b128 v[24:27], v16 offset:0
    ds_read_b64_tr_b16 v[32:33], v19 offset:2048
    ds_read_b64_tr_b16 v[34:35], v19 offset:2560
    s_waitcnt lgkmcnt(3)
    v_mfma_f32_32x32x16_bf16 v[36:51], v[28:31], v[20:23], v[36:51]
    ds_read_b128 v[20:23], v17 offset:0
    ds_read_b64_tr_b16 v[28:29], v19 offset:4096
    ds_read_b64_tr_b16 v[30:31], v19 offset:4608
    s_waitcnt lgkmcnt(3)
    v_mfma_f32_32x32x16_bf16 v[36:51], v[32:35], v[24:27], v[36:51]
    ds_read_b128 v[24:27], v18 offset:0
    ds_read_b64_tr_b16 v[32:33], v19 offset:6144
    ds_read_b64_tr_b16 v[34:35], v19 offset:6656
    s_waitcnt lgkmcnt(3)
    v_mfma_f32_32x32x16_bf16 v[36:51], v[28:31], v[20:23], v[36:51]
    v_add_u32 v15, 49152, v10
    v_add_u32 v16, 49152, v11
    v_add_u32 v17, 49152, v12
    v_add_u32 v18, 49152, v13
    v_add_u32 v19, 49152, v14
    ds_read_b128 v[20:23], v15 offset:0
    ds_read_b64_tr_b16 v[28:29], v19 offset:0
    ds_read_b64_tr_b16 v[30:31], v19 offset:512
    s_waitcnt lgkmcnt(3)
    v_mfma_f32_32x32x16_bf16 v[36:51], v[32:35], v[24:27], v[36:51]
    s_waitcnt vmcnt(12)
    s_barrier
    s_add_u32 s22, s26, 32768
    s_mov_b32 m0, s22
    s_add_u32 s23, s20, 0
    buffer_load_dwordx4 v2, s[4:7], s23 offen lds
    s_add_u32 s22, s26, 33792
    s_mov_b32 m0, s22
    s_add_u32 s23, s20, 66560
    buffer_load_dwordx4 v3, s[4:7], s23 offen lds
    s_add_u32 s22, s27, 32768
    s_mov_b32 m0, s22
    s_add_u32 s23, s21, 0
    buffer_load_dwordx4 v4, s[8:11], s23 offen lds
    s_add_u32 s22, s27, 33792
    s_mov_b32 m0, s22
    s_add_u32 s23, s21, 9216
    buffer_load_dwordx4 v4, s[8:11], s23 offen lds
    s_add_u32 s20, s20, 128
    s_add_u32 s21, s21, 73728
    ds_read_b128 v[24:27], v16 offset:0
    ds_read_b64_tr_b16 v[32:33], v19 offset:2048
    ds_read_b64_tr_b16 v[34:35], v19 offset:2560
    s_waitcnt lgkmcnt(3)
    v_mfma_f32_32x32x16_bf16 v[36:51], v[28:31], v[20:23], v[36:51]
    ds_read_b128 v[20:23], v17 offset:0
    ds_read_b64_tr_b16 v[28:29], v19 offset:4096
    ds_read_b64_tr_b16 v[30:31], v19 offset:4608
    s_waitcnt lgkmcnt(3)
    v_mfma_f32_32x32x16_bf16 v[36:51], v[32:35], v[24:27], v[36:51]
    ds_read_b128 v[24:27], v18 offset:0
    ds_read_b64_tr_b16 v[32:33], v19 offset:6144
    ds_read_b64_tr_b16 v[34:35], v19 offset:6656
    s_waitcnt lgkmcnt(3)
    v_mfma_f32_32x32x16_bf16 v[36:51], v[28:31], v[20:23], v[36:51]
    v_add_u32 v15, 65536, v10
    v_add_u32 v16, 65536, v11
    v_add_u32 v17, 65536, v12
    v_add_u32 v18, 65536, v13
    v_add_u32 v19, 65536, v14
    ds_read_b128 v[20:23], v15 offset:0
    ds_read_b64_tr_b16 v[28:29], v19 offset:0
    ds_read_b64_tr_b16 v[30:31], v19 offset:512
    s_waitcnt lgkmcnt(3)
    v_mfma_f32_32x32x16_bf16 v[36:51], v[32:35], v[24:27], v[36:51]
    s_waitcnt vmcnt(12)
    s_barrier
    s_add_u32 s22, s26, 49152
    s_mov_b32 m0, s22
    s_add_u32 s23, s20, 0
    buffer_load_dwordx4 v2, s[4:7], s23 offen lds
    s_add_u32 s22, s26, 50176
    s_mov_b32 m0, s22
    s_add_u32 s23, s20, 66560
    buffer_load_dwordx4 v3, s[4:7], s23 offen lds
    s_add_u32 s22, s27, 49152
    s_mov_b32 m0, s22
    s_add_u32 s23, s21, 0
    buffer_load_dwordx4 v4, s[8:11], s23 offen lds
    s_add_u32 s22, s27, 50176
    s_mov_b32 m0, s22
    s_add_u32 s23, s21, 9216
    buffer_load_dwordx4 v4, s[8:11], s23 offen lds
    s_add_u32 s20, s20, 128
    s_add_u32 s21, s21, 73728
    ds_read_b128 v[24:27], v16 offset:0
    ds_read_b64_tr_b16 v[32:33], v19 offset:2048
    ds_read_b64_tr_b16 v[34:35], v19 offset:2560
    s_waitcnt lgkmcnt(3)
    v_mfma_f32_32x32x16_bf16 v[36:51], v[28:31], v[20:23], v[36:51]
    ds_read_b128 v[20:23], v17 offset:0
    ds_read_b64_tr_b16 v[28:29], v19 offset:4096
    ds_read_b64_tr_b16 v[30:31], v19 offset:4608
    s_waitcnt lgkmcnt(3)
    v_mfma_f32_32x32x16_bf16 v[36:51], v[32:35], v[24:27], v[36:51]
    ds_read_b128 v[24:27], v18 offset:0
    ds_read_b64_tr_b16 v[32:33], v19 offset:6144
    ds_read_b64_tr_b16 v[34:35], v19 offset:6656
    s_waitcnt lgkmcnt(3)
    v_mfma_f32_32x32x16_bf16 v[36:51], v[28:31], v[20:23], v[36:51]
    v_add_u32 v15, 81920, v10
    v_add_u32 v16, 81920, v11
    v_add_u32 v17, 81920, v12
    v_add_u32 v18, 81920, v13
    v_add_u32 v19, 81920, v14
    ds_read_b128 v[20:23], v15 offset:0
    ds_read_b64_tr_b16 v[28:29], v19 offset:0
    ds_read_b64_tr_b16 v[30:31], v19 offset:512
    s_waitcnt lgkmcnt(3)
    v_mfma_f32_32x32x16_bf16 v[36:51], v[32:35], v[24:27], v[36:51]
    s_waitcnt vmcnt(12)
    s_barrier
    s_add_u32 s22, s26, 65536
    s_mov_b32 m0, s22
    s_add_u32 s23, s20, 0
    buffer_load_dwordx4 v2, s[4:7], s23 offen lds
    s_add_u32 s22, s26, 66560
    s_mov_b32 m0, s22
    s_add_u32 s23, s20, 66560
    buffer_load_dwordx4 v3, s[4:7], s23 offen lds
    s_add_u32 s22, s27, 65536
    s_mov_b32 m0, s22
    s_add_u32 s23, s21, 0
    buffer_load_dwordx4 v4, s[8:11], s23 offen lds
    s_add_u32 s22, s27, 66560
    s_mov_b32 m0, s22
    s_add_u32 s23, s21, 9216
    buffer_load_dwordx4 v4, s[8:11], s23 offen lds
    s_add_u32 s20, s20, 128
    s_add_u32 s21, s21, 73728
    ds_read_b128 v[24:27], v16 offset:0
    ds_read_b64_tr_b16 v[32:33], v19 offset:2048
    ds_read_b64_tr_b16 v[34:35], v19 offset:2560
    s_waitcnt lgkmcnt(3)
    v_mfma_f32_32x32x16_bf16 v[36:51], v[28:31], v[20:23], v[36:51]
    ds_read_b128 v[20:23], v17 offset:0
    ds_read_b64_tr_b16 v[28:29], v19 offset:4096
    ds_read_b64_tr_b16 v[30:31], v19 offset:4608
    s_waitcnt lgkmcnt(3)
    v_mfma_f32_32x32x16_bf16 v[36:51], v[32:35], v[24:27], v[36:51]
    ds_read_b128 v[24:27], v18 offset:0
    ds_read_b64_tr_b16 v[32:33], v19 offset:6144
    ds_read_b64_tr_b16 v[34:35], v19 offset:6656
    s_waitcnt lgkmcnt(3)
    v_mfma_f32_32x32x16_bf16 v[36:51], v[28:31], v[20:23], v[36:51]
    v_add_u32 v15, 0, v10
    v_add_u32 v16, 0, v11
    v_add_u32 v17, 0, v12
    v_add_u32 v18, 0, v13
    v_add_u32 v19, 0, v14
    ds_read_b128 v[20:23], v15 offset:0
    ds_read_b64_tr_b16 v[28:29], v19 offset:0
    ds_read_b64_tr_b16 v[30:31], v19 offset:512
    s_waitcnt lgkmcnt(3)
    v_mfma_f32_32x32x16_bf16 v[36:51], v[32:35], v[24:27], v[36:51]
    s_sub_u32 s25, s25, 1
    s_cmp_lg_u32 s25, 0
    s_cbranch_scc1 oproj_kernel_loop
    s_waitcnt vmcnt(12)
    s_barrier
    s_add_u32 s22, s26, 81920
    s_mov_b32 m0, s22
    s_add_u32 s23, s20, 0
    buffer_load_dwordx4 v2, s[4:7], s23 offen lds
    s_add_u32 s22, s26, 82944
    s_mov_b32 m0, s22
    s_add_u32 s23, s20, 66560
    buffer_load_dwordx4 v3, s[4:7], s23 offen lds
    s_add_u32 s22, s27, 81920
    s_mov_b32 m0, s22
    s_add_u32 s23, s21, 0
    buffer_load_dwordx4 v4, s[8:11], s23 offen lds
    s_add_u32 s22, s27, 82944
    s_mov_b32 m0, s22
    s_add_u32 s23, s21, 9216
    buffer_load_dwordx4 v4, s[8:11], s23 offen lds
    s_add_u32 s20, s20, 128
    s_add_u32 s21, s21, 73728
    ds_read_b128 v[24:27], v16 offset:0
    ds_read_b64_tr_b16 v[32:33], v19 offset:2048
    ds_read_b64_tr_b16 v[34:35], v19 offset:2560
    s_waitcnt lgkmcnt(3)
    v_mfma_f32_32x32x16_bf16 v[36:51], v[28:31], v[20:23], v[36:51]
    ds_read_b128 v[20:23], v17 offset:0
    ds_read_b64_tr_b16 v[28:29], v19 offset:4096
    ds_read_b64_tr_b16 v[30:31], v19 offset:4608
    s_waitcnt lgkmcnt(3)
    v_mfma_f32_32x32x16_bf16 v[36:51], v[32:35], v[24:27], v[36:51]
    ds_read_b128 v[24:27], v18 offset:0
    ds_read_b64_tr_b16 v[32:33], v19 offset:6144
    ds_read_b64_tr_b16 v[34:35], v19 offset:6656
    s_waitcnt lgkmcnt(3)
    v_mfma_f32_32x32x16_bf16 v[36:51], v[28:31], v[20:23], v[36:51]
    v_add_u32 v15, 16384, v10
    v_add_u32 v16, 16384, v11
    v_add_u32 v17, 16384, v12
    v_add_u32 v18, 16384, v13
    v_add_u32 v19, 16384, v14
    ds_read_b128 v[20:23], v15 offset:0
    ds_read_b64_tr_b16 v[28:29], v19 offset:0
    ds_read_b64_tr_b16 v[30:31], v19 offset:512
    s_waitcnt lgkmcnt(3)
    v_mfma_f32_32x32x16_bf16 v[36:51], v[32:35], v[24:27], v[36:51]
    s_waitcnt vmcnt(12)
    s_barrier
    s_add_u32 s22, s26, 0
    s_mov_b32 m0, s22
    s_add_u32 s23, s20, 0
    buffer_load_dwordx4 v2, s[4:7], s23 offen lds
    s_add_u32 s22, s26, 1024
    s_mov_b32 m0, s22
    s_add_u32 s23, s20, 66560
    buffer_load_dwordx4 v3, s[4:7], s23 offen lds
    s_add_u32 s22, s27, 0
    s_mov_b32 m0, s22
    s_add_u32 s23, s21, 0
    buffer_load_dwordx4 v4, s[8:11], s23 offen lds
    s_add_u32 s22, s27, 1024
    s_mov_b32 m0, s22
    s_add_u32 s23, s21, 9216
    buffer_load_dwordx4 v4, s[8:11], s23 offen lds
    s_add_u32 s20, s20, 128
    s_add_u32 s21, s21, 73728
    ds_read_b128 v[24:27], v16 offset:0
    ds_read_b64_tr_b16 v[32:33], v19 offset:2048
    ds_read_b64_tr_b16 v[34:35], v19 offset:2560
    s_waitcnt lgkmcnt(3)
    v_mfma_f32_32x32x16_bf16 v[36:51], v[28:31], v[20:23], v[36:51]
    ds_read_b128 v[20:23], v17 offset:0
    ds_read_b64_tr_b16 v[28:29], v19 offset:4096
    ds_read_b64_tr_b16 v[30:31], v19 offset:4608
    s_waitcnt lgkmcnt(3)
    v_mfma_f32_32x32x16_bf16 v[36:51], v[32:35], v[24:27], v[36:51]
    ds_read_b128 v[24:27], v18 offset:0
    ds_read_b64_tr_b16 v[32:33], v19 offset:6144
    ds_read_b64_tr_b16 v[34:35], v19 offset:6656
    s_waitcnt lgkmcnt(3)
    v_mfma_f32_32x32x16_bf16 v[36:51], v[28:31], v[20:23], v[36:51]
    v_add_u32 v15, 32768, v10
    v_add_u32 v16, 32768, v11
    v_add_u32 v17, 32768, v12
    v_add_u32 v18, 32768, v13
    v_add_u32 v19, 32768, v14
    ds_read_b128 v[20:23], v15 offset:0
    ds_read_b64_tr_b16 v[28:29], v19 offset:0
    ds_read_b64_tr_b16 v[30:31], v19 offset:512
    s_waitcnt lgkmcnt(3)
    v_mfma_f32_32x32x16_bf16 v[36:51], v[32:35], v[24:27], v[36:51]
    s_waitcnt vmcnt(12)
    s_barrier
    s_add_u32 s22, s26, 16384
    s_mov_b32 m0, s22
    s_add_u32 s23, s20, 0
    buffer_load_dwordx4 v2, s[4:7], s23 offen lds
    s_add_u32 s22, s26, 17408
    s_mov_b32 m0, s22
    s_add_u32 s23, s20, 66560
    buffer_load_dwordx4 v3, s[4:7], s23 offen lds
    s_add_u32 s22, s27, 16384
    s_mov_b32 m0, s22
    s_add_u32 s23, s21, 0
    buffer_load_dwordx4 v4, s[8:11], s23 offen lds
    s_add_u32 s22, s27, 17408
    s_mov_b32 m0, s22
    s_add_u32 s23, s21, 9216
    buffer_load_dwordx4 v4, s[8:11], s23 offen lds
    s_add_u32 s20, s20, 128
    s_add_u32 s21, s21, 73728
    ds_read_b128 v[24:27], v16 offset:0
    ds_read_b64_tr_b16 v[32:33], v19 offset:2048
    ds_read_b64_tr_b16 v[34:35], v19 offset:2560
    s_waitcnt lgkmcnt(3)
    v_mfma_f32_32x32x16_bf16 v[36:51], v[28:31], v[20:23], v[36:51]
    ds_read_b128 v[20:23], v17 offset:0
    ds_read_b64_tr_b16 v[28:29], v19 offset:4096
    ds_read_b64_tr_b16 v[30:31], v19 offset:4608
    s_waitcnt lgkmcnt(3)
    v_mfma_f32_32x32x16_bf16 v[36:51], v[32:35], v[24:27], v[36:51]
    ds_read_b128 v[24:27], v18 offset:0
    ds_read_b64_tr_b16 v[32:33], v19 offset:6144
    ds_read_b64_tr_b16 v[34:35], v19 offset:6656
    s_waitcnt lgkmcnt(3)
    v_mfma_f32_32x32x16_bf16 v[36:51], v[28:31], v[20:23], v[36:51]
    v_add_u32 v15, 49152, v10
    v_add_u32 v16, 49152, v11
    v_add_u32 v17, 49152, v12
    v_add_u32 v18, 49152, v13
    v_add_u32 v19, 49152, v14
    ds_read_b128 v[20:23], v15 offset:0
    ds_read_b64_tr_b16 v[28:29], v19 offset:0
    ds_read_b64_tr_b16 v[30:31], v19 offset:512
    s_waitcnt lgkmcnt(3)
    v_mfma_f32_32x32x16_bf16 v[36:51], v[32:35], v[24:27], v[36:51]
    s_waitcnt vmcnt(12)
    s_barrier
    s_add_u32 s22, s26, 32768
    s_mov_b32 m0, s22
    s_add_u32 s23, s20, 0
    buffer_load_dwordx4 v2, s[4:7], s23 offen lds
    s_add_u32 s22, s26, 33792
    s_mov_b32 m0, s22
    s_add_u32 s23, s20, 66560
    buffer_load_dwordx4 v3, s[4:7], s23 offen lds
    s_add_u32 s22, s27, 32768
    s_mov_b32 m0, s22
    s_add_u32 s23, s21, 0
    buffer_load_dwordx4 v4, s[8:11], s23 offen lds
    s_add_u32 s22, s27, 33792
    s_mov_b32 m0, s22
    s_add_u32 s23, s21, 9216
    buffer_load_dwordx4 v4, s[8:11], s23 offen lds
    s_add_u32 s20, s20, 128
    s_add_u32 s21, s21, 73728
    ds_read_b128 v[24:27], v16 offset:0
    ds_read_b64_tr_b16 v[32:33], v19 offset:2048
    ds_read_b64_tr_b16 v[34:35], v19 offset:2560
    s_waitcnt lgkmcnt(3)
    v_mfma_f32_32x32x16_bf16 v[36:51], v[28:31], v[20:23], v[36:51]
    ds_read_b128 v[20:23], v17 offset:0
    ds_read_b64_tr_b16 v[28:29], v19 offset:4096
    ds_read_b64_tr_b16 v[30:31], v19 offset:4608
    s_waitcnt lgkmcnt(3)
    v_mfma_f32_32x32x16_bf16 v[36:51], v[32:35], v[24:27], v[36:51]
    ds_read_b128 v[24:27], v18 offset:0
    ds_read_b64_tr_b16 v[32:33], v19 offset:6144
    ds_read_b64_tr_b16 v[34:35], v19 offset:6656
    s_waitcnt lgkmcnt(3)
    v_mfma_f32_32x32x16_bf16 v[36:51], v[28:31], v[20:23], v[36:51]
    v_add_u32 v15, 65536, v10
    v_add_u32 v16, 65536, v11
    v_add_u32 v17, 65536, v12
    v_add_u32 v18, 65536, v13
    v_add_u32 v19, 65536, v14
    ds_read_b128 v[20:23], v15 offset:0
    ds_read_b64_tr_b16 v[28:29], v19 offset:0
    ds_read_b64_tr_b16 v[30:31], v19 offset:512
    s_waitcnt lgkmcnt(3)
    v_mfma_f32_32x32x16_bf16 v[36:51], v[32:35], v[24:27], v[36:51]
    s_waitcnt vmcnt(12)
    s_barrier
    s_add_u32 s22, s26, 49152
    s_mov_b32 m0, s22
    s_add_u32 s23, s20, 0
    buffer_load_dwordx4 v2, s[4:7], s23 offen lds
    s_add_u32 s22, s26, 50176
    s_mov_b32 m0, s22
    s_add_u32 s23, s20, 66560
    buffer_load_dwordx4 v3, s[4:7], s23 offen lds
    s_add_u32 s22, s27, 49152
    s_mov_b32 m0, s22
    s_add_u32 s23, s21, 0
    buffer_load_dwordx4 v4, s[8:11], s23 offen lds
    s_add_u32 s22, s27, 50176
    s_mov_b32 m0, s22
    s_add_u32 s23, s21, 9216
    buffer_load_dwordx4 v4, s[8:11], s23 offen lds
    s_add_u32 s20, s20, 128
    s_add_u32 s21, s21, 73728
    ds_read_b128 v[24:27], v16 offset:0
    ds_read_b64_tr_b16 v[32:33], v19 offset:2048
    ds_read_b64_tr_b16 v[34:35], v19 offset:2560
    s_waitcnt lgkmcnt(3)
    v_mfma_f32_32x32x16_bf16 v[36:51], v[28:31], v[20:23], v[36:51]
    ds_read_b128 v[20:23], v17 offset:0
    ds_read_b64_tr_b16 v[28:29], v19 offset:4096
    ds_read_b64_tr_b16 v[30:31], v19 offset:4608
    s_waitcnt lgkmcnt(3)
    v_mfma_f32_32x32x16_bf16 v[36:51], v[32:35], v[24:27], v[36:51]
    ds_read_b128 v[24:27], v18 offset:0
    ds_read_b64_tr_b16 v[32:33], v19 offset:6144
    ds_read_b64_tr_b16 v[34:35], v19 offset:6656
    s_waitcnt lgkmcnt(3)
    v_mfma_f32_32x32x16_bf16 v[36:51], v[28:31], v[20:23], v[36:51]
    v_add_u32 v15, 81920, v10
    v_add_u32 v16, 81920, v11
    v_add_u32 v17, 81920, v12
    v_add_u32 v18, 81920, v13
    v_add_u32 v19, 81920, v14
    ds_read_b128 v[20:23], v15 offset:0
    ds_read_b64_tr_b16 v[28:29], v19 offset:0
    ds_read_b64_tr_b16 v[30:31], v19 offset:512
    s_waitcnt lgkmcnt(3)
    v_mfma_f32_32x32x16_bf16 v[36:51], v[32:35], v[24:27], v[36:51]
    s_waitcnt vmcnt(12)
    s_barrier
    ds_read_b128 v[24:27], v16 offset:0
    ds_read_b64_tr_b16 v[32:33], v19 offset:2048
    ds_read_b64_tr_b16 v[34:35], v19 offset:2560
    s_waitcnt lgkmcnt(3)
    v_mfma_f32_32x32x16_bf16 v[36:51], v[28:31], v[20:23], v[36:51]
    ds_read_b128 v[20:23], v17 offset:0
    ds_read_b64_tr_b16 v[28:29], v19 offset:4096
    ds_read_b64_tr_b16 v[30:31], v19 offset:4608
    s_waitcnt lgkmcnt(3)
    v_mfma_f32_32x32x16_bf16 v[36:51], v[32:35], v[24:27], v[36:51]
    ds_read_b128 v[24:27], v18 offset:0
    ds_read_b64_tr_b16 v[32:33], v19 offset:6144
    ds_read_b64_tr_b16 v[34:35], v19 offset:6656
    s_waitcnt lgkmcnt(3)
    v_mfma_f32_32x32x16_bf16 v[36:51], v[28:31], v[20:23], v[36:51]
    v_add_u32 v15, 0, v10
    v_add_u32 v16, 0, v11
    v_add_u32 v17, 0, v12
    v_add_u32 v18, 0, v13
    v_add_u32 v19, 0, v14
    ds_read_b128 v[20:23], v15 offset:0
    ds_read_b64_tr_b16 v[28:29], v19 offset:0
    ds_read_b64_tr_b16 v[30:31], v19 offset:512
    s_waitcnt lgkmcnt(3)
    v_mfma_f32_32x32x16_bf16 v[36:51], v[32:35], v[24:27], v[36:51]
    s_waitcnt vmcnt(8)
    s_barrier
    ds_read_b128 v[24:27], v16 offset:0
    ds_read_b64_tr_b16 v[32:33], v19 offset:2048
    ds_read_b64_tr_b16 v[34:35], v19 offset:2560
    s_waitcnt lgkmcnt(3)
    v_mfma_f32_32x32x16_bf16 v[36:51], v[28:31], v[20:23], v[36:51]
    ds_read_b128 v[20:23], v17 offset:0
    ds_read_b64_tr_b16 v[28:29], v19 offset:4096
    ds_read_b64_tr_b16 v[30:31], v19 offset:4608
    s_waitcnt lgkmcnt(3)
    v_mfma_f32_32x32x16_bf16 v[36:51], v[32:35], v[24:27], v[36:51]
    ds_read_b128 v[24:27], v18 offset:0
    ds_read_b64_tr_b16 v[32:33], v19 offset:6144
    ds_read_b64_tr_b16 v[34:35], v19 offset:6656
    s_waitcnt lgkmcnt(3)
    v_mfma_f32_32x32x16_bf16 v[36:51], v[28:31], v[20:23], v[36:51]
    v_add_u32 v15, 16384, v10
    v_add_u32 v16, 16384, v11
    v_add_u32 v17, 16384, v12
    v_add_u32 v18, 16384, v13
    v_add_u32 v19, 16384, v14
    ds_read_b128 v[20:23], v15 offset:0
    ds_read_b64_tr_b16 v[28:29], v19 offset:0
    ds_read_b64_tr_b16 v[30:31], v19 offset:512
    s_waitcnt lgkmcnt(3)
    v_mfma_f32_32x32x16_bf16 v[36:51], v[32:35], v[24:27], v[36:51]
    s_waitcnt vmcnt(4)
    s_barrier
    ds_read_b128 v[24:27], v16 offset:0
    ds_read_b64_tr_b16 v[32:33], v19 offset:2048
    ds_read_b64_tr_b16 v[34:35], v19 offset:2560
    s_waitcnt lgkmcnt(3)
    v_mfma_f32_32x32x16_bf16 v[36:51], v[28:31], v[20:23], v[36:51]
    ds_read_b128 v[20:23], v17 offset:0
    ds_read_b64_tr_b16 v[28:29], v19 offset:4096
    ds_read_b64_tr_b16 v[30:31], v19 offset:4608
    s_waitcnt lgkmcnt(3)
    v_mfma_f32_32x32x16_bf16 v[36:51], v[32:35], v[24:27], v[36:51]
    ds_read_b128 v[24:27], v18 offset:0
    ds_read_b64_tr_b16 v[32:33], v19 offset:6144
    ds_read_b64_tr_b16 v[34:35], v19 offset:6656
    s_waitcnt lgkmcnt(3)
    v_mfma_f32_32x32x16_bf16 v[36:51], v[28:31], v[20:23], v[36:51]
    v_add_u32 v15, 32768, v10
    v_add_u32 v16, 32768, v11
    v_add_u32 v17, 32768, v12
    v_add_u32 v18, 32768, v13
    v_add_u32 v19, 32768, v14
    ds_read_b128 v[20:23], v15 offset:0
    ds_read_b64_tr_b16 v[28:29], v19 offset:0
    ds_read_b64_tr_b16 v[30:31], v19 offset:512
    s_waitcnt lgkmcnt(3)
    v_mfma_f32_32x32x16_bf16 v[36:51], v[32:35], v[24:27], v[36:51]
    s_waitcnt vmcnt(0)
    s_barrier
    ds_read_b128 v[24:27], v16 offset:0
    ds_read_b64_tr_b16 v[32:33], v19 offset:2048
    ds_read_b64_tr_b16 v[34:35], v19 offset:2560
    s_waitcnt lgkmcnt(3)
    v_mfma_f32_32x32x16_bf16 v[36:51], v[28:31], v[20:23], v[36:51]
    ds_read_b128 v[20:23], v17 offset:0
    ds_read_b64_tr_b16 v[28:29], v19 offset:4096
    ds_read_b64_tr_b16 v[30:31], v19 offset:4608
    s_waitcnt lgkmcnt(3)
    v_mfma_f32_32x32x16_bf16 v[36:51], v[32:35], v[24:27], v[36:51]
    ds_read_b128 v[24:27], v18 offset:0
    ds_read_b64_tr_b16 v[32:33], v19 offset:6144
    ds_read_b64_tr_b16 v[34:35], v19 offset:6656
    s_waitcnt lgkmcnt(3)
    v_mfma_f32_32x32x16_bf16 v[36:51], v[28:31], v[20:23], v[36:51]
    v_add_u32 v15, 49152, v10
    v_add_u32 v16, 49152, v11
    v_add_u32 v17, 49152, v12
    v_add_u32 v18, 49152, v13
    v_add_u32 v19, 49152, v14
    ds_read_b128 v[20:23], v15 offset:0
    ds_read_b64_tr_b16 v[28:29], v19 offset:0
    ds_read_b64_tr_b16 v[30:31], v19 offset:512
    s_waitcnt lgkmcnt(3)
    v_mfma_f32_32x32x16_bf16 v[36:51], v[32:35], v[24:27], v[36:51]
    ds_read_b128 v[24:27], v16 offset:0
    ds_read_b64_tr_b16 v[32:33], v19 offset:2048
    ds_read_b64_tr_b16 v[34:35], v19 offset:2560
    s_waitcnt lgkmcnt(3)
    v_mfma_f32_32x32x16_bf16 v[36:51], v[28:31], v[20:23], v[36:51]
    ds_read_b128 v[20:23], v17 offset:0
    ds_read_b64_tr_b16 v[28:29], v19 offset:4096
    ds_read_b64_tr_b16 v[30:31], v19 offset:4608
    s_waitcnt lgkmcnt(3)
    v_mfma_f32_32x32x16_bf16 v[36:51], v[32:35], v[24:27], v[36:51]
    ds_read_b128 v[24:27], v18 offset:0
    ds_read_b64_tr_b16 v[32:33], v19 offset:6144
    ds_read_b64_tr_b16 v[34:35], v19 offset:6656
    s_waitcnt lgkmcnt(3)
    v_mfma_f32_32x32x16_bf16 v[36:51], v[28:31], v[20:23], v[36:51]
    s_waitcnt lgkmcnt(0)
    v_mfma_f32_32x32x16_bf16 v[36:51], v[32:35], v[24:27], v[36:51]
    s_nop 7
    s_nop 7
    s_lshr_b32 s22, s18, 1
    s_and_b32 s23, s18, 1
    s_mul_i32 s22, s22, 32
    s_mul_i32 s23, s23, 64
    v_and_b32 v6, 31, v1
    v_add_u32 v6, s22, v6
    s_mov_b32 s24, 1152
    v_mul_lo_u32 v5, v6, s24
    v_lshrrev_b32 v6, 5, v1
    v_lshl_add_u32 v5, v6, 3, v5
    v_add_u32 v5, s23, v5
    s_add_u32 s22, s16, 0
    s_mul_i32 s28, s22, 1152
    s_lshl_b32 s22, s17, 1
    s_add_u32 s28, s28, s22
    v_cvt_pk_bf16_f32 v20, v36, v37
    v_cvt_pk_bf16_f32 v21, v38, v39
    buffer_store_dwordx2 v[20:21], v5, s[12:15], s28 offen offset:0
    v_cvt_pk_bf16_f32 v22, v40, v41
    v_cvt_pk_bf16_f32 v23, v42, v43
    buffer_store_dwordx2 v[22:23], v5, s[12:15], s28 offen offset:16
    v_cvt_pk_bf16_f32 v24, v44, v45
    v_cvt_pk_bf16_f32 v25, v46, v47
    buffer_store_dwordx2 v[24:25], v5, s[12:15], s28 offen offset:32
    v_cvt_pk_bf16_f32 v26, v48, v49
    v_cvt_pk_bf16_f32 v27, v50, v51
    buffer_store_dwordx2 v[26:27], v5, s[12:15], s28 offen offset:48
oproj_kernel_done:
    s_endpgm
.section .rodata,"a"
.p2align 6
.amdhsa_kernel attn_kernel
  .amdhsa_next_free_vgpr 240
  .amdhsa_next_free_sgpr 102
  .amdhsa_accum_offset 240
  .amdhsa_group_segment_fixed_size 0
  .amdhsa_kernarg_size 64
  .amdhsa_user_sgpr_count 2
  .amdhsa_user_sgpr_kernarg_segment_ptr 1
  .amdhsa_system_sgpr_workgroup_id_x 1
.end_amdhsa_kernel
.section .rodata,"a"
.p2align 6
.amdhsa_kernel oproj_kernel
  .amdhsa_next_free_vgpr 52
  .amdhsa_next_free_sgpr 102
  .amdhsa_accum_offset 52
  .amdhsa_group_segment_fixed_size 0
  .amdhsa_kernarg_size 64
  .amdhsa_user_sgpr_count 2
  .amdhsa_user_sgpr_kernarg_segment_ptr 1
  .amdhsa_system_sgpr_workgroup_id_x 1
.end_amdhsa_kernel
```
